```python
import torch

def _softmax(x, axis=-1):
    return torch.softmax(x, dim=axis)
def _gelu(x):
    return torch.nn.functional.gelu(x, approximate="tanh")
def _silu(x):
    return torch.nn.functional.silu(x)
def _sigmoid(x):
    return torch.sigmoid(x)
def _layernorm(x, axis=-1, eps=1e-5):
    m = x.mean(dim=axis, keepdim=True)
    v = x.var(dim=axis, keepdim=True, unbiased=False)
    return (x - m) / torch.sqrt(v + eps)
def _scatter_add(tgt, idx, src, axis=0):
    return tgt.clone().index_add_(axis, idx, src)
def _segment_sum(src, seg, n):
    out = torch.zeros((n,) + src.shape[1:], dtype=src.dtype)
    return out.index_add_(0, seg, src)
def _pad(x, pw):
    flat = tuple(v for pair in reversed(pw) for v in pair)
    return torch.nn.functional.pad(x, flat)

kernel_name = 'gated_mix__grouped_kv_mqa__glu_gated_geglu__prompt'

def setup_inputs():

    _w = (lambda a: (lambda t: t.to(torch.bfloat16) if t.is_floating_point() else t)(torch.as_tensor(a)))
    def _A_setup():
        B, S, D, H = 1, 2048, 512, 32
        Dh = D // H
        return {
            "x": _w((lambda *s: torch.randn(*s, dtype=torch.bfloat16) * 0.05)(B, S, D)),
            "wq": _w((lambda *s: torch.randn(*s, dtype=torch.bfloat16) * 0.8)(D, H * Dh)),
            "wk": _w((lambda *s: torch.randn(*s, dtype=torch.bfloat16) * 0.8)(D, Dh)),
            "wv": _w((lambda *s: torch.randn(*s, dtype=torch.bfloat16) * 0.05)(D, Dh)),
            "wo": _w((lambda *s: torch.randn(*s, dtype=torch.bfloat16) * 0.05)(H * Dh, D)),
        }
    _A_in = _A_setup()

    def _B_setup():
        B, S, Dm, Df = 1, 2048, 512, 1792
        return {
            "x": _w((lambda *s: torch.randn(*s, dtype=torch.bfloat16) * 0.05)(B, S, Dm)),
            "w_gate": _w((lambda *s: torch.randn(*s, dtype=torch.bfloat16) * 0.8)(Dm, Df) * (Dm ** -0.5)),
            "w_up": _w((lambda *s: torch.randn(*s, dtype=torch.bfloat16) * 0.8)(Dm, Df) * (Dm ** -0.5)),
            "w_down": _w((lambda *s: torch.randn(*s, dtype=torch.bfloat16) * 0.8)(Df, Dm) * (Df ** -0.5)),
        }
    _B_in = _B_setup()

    return {
        "A_x": _A_in["x"],
        "A_wq": _A_in["wq"],
        "A_wk": _A_in["wk"],
        "A_wv": _A_in["wv"],
        "A_wo": _A_in["wo"],
        "B_x": _B_in["x"],
        "B_w_gate": _B_in["w_gate"],
        "B_w_up": _B_in["w_up"],
        "B_w_down": _B_in["w_down"],
        "gate_w": _w((lambda *s: torch.randn(*s, dtype=torch.bfloat16) * 0.05)(512) * 16.0),
    }

def reference(A_x, A_wq, A_wk, A_wv, A_wo, B_x, B_w_gate, B_w_up, B_w_down, gate_w):
    def _A_ref(x, wq, wk, wv, wo):
        B, S, D = x.shape
        H = 32
        Dh = D // H
        q = (lambda x, *d: x.permute(*d))((x @ wq).reshape(B, S, H, Dh), 0, 2, 1, 3)
        k = x @ wk
        v = x @ wv
        scores = torch.einsum("bhqd,bkd->bhqk", q, k) * (Dh ** -0.5)
        p = _softmax(scores, axis=-1)
        o = torch.einsum("bhqk,bkd->bhqd", p, v)
        return (lambda x, *d: x.permute(*d))(o, 0, 2, 1, 3).reshape(B, S, H * Dh) @ wo

    def _B_ref(x, w_gate, w_up, w_down):
        g = torch.einsum("bsd,df->bsf", x, w_gate)
        u = torch.einsum("bsd,df->bsf", x, w_up)
        h = _gelu(g) * u
        return torch.einsum("bsf,fd->bsd", h, w_down)

    x = A_x
    g = _sigmoid((x * gate_w).sum(-1, keepdims=True))
    a = _A_ref(x, A_wq, A_wk, A_wv, A_wo)
    b = _B_ref(x, B_w_gate, B_w_up, B_w_down)
    return g * a + (1 - g) * b
```

```asm
; @launch grid=(256,1,1) block=(512,1,1) lds=163840
.amdgcn_target "amdgcn-amd-amdhsa--gfx950"
.text
.globl gated_mix__grouped_kv_mqa__glu_gated_geglu__prompt_kernel
.p2align 8
.type gated_mix__grouped_kv_mqa__glu_gated_geglu__prompt_kernel,@function
gated_mix__grouped_kv_mqa__glu_gated_geglu__prompt_kernel:
    s_cmp_ge_u32 s2, 256
    s_cbranch_scc1 L_end
    s_load_dwordx16 s[72:87], s[0:1], 0
    s_load_dwordx8 s[88:95], s[0:1], 64
    s_load_dwordx2 s[96:97], s[0:1], 96
    v_lshrrev_b32 v1, 6, v0
    v_and_b32 v2, 63, v0
    v_lshlrev_b32 v3, 4, v2
    v_readfirstlane_b32 s44, v1
    s_and_b32 s98, s2, 7
    s_lshr_b32 s99, s2, 3
    s_lshr_b32 s47, s98, 1
    s_lshl_b32 s47, s47, 2
    s_and_b32 s100, s99, 3
    s_add_u32 s47, s47, s100
    s_and_b32 s48, s98, 1
    s_lshl_b32 s48, s48, 3
    s_lshr_b32 s100, s99, 2
    s_add_u32 s48, s48, s100
    s_lshr_b32 s45, s44, 2
    s_mov_b32 s6, 0x200000
    s_mov_b32 s7, 0x20000
    s_mov_b32 s14, 16384
    s_mov_b32 s15, 0x20000
    s_mov_b32 s34, 1024
    s_mov_b32 s35, 0x20000
    s_cmp_eq_u32 s45, 1
    s_cbranch_scc1 L_init_1
    v_lshrrev_b32 v11, 4, v2
    v_and_b32 v12, 15, v2
    v_lshlrev_b32 v12, 4, v12
    v_lshl_add_u32 v11, v11, 12, v12
    s_lshr_b32 s99, s48, 1
    s_lshl_b32 s99, s99, 14
    s_lshl_b32 s100, s47, 17
    s_add_u32 s99, s99, s100
    s_lshl_b32 s100, s44, 8
    s_add_u32 s99, s99, s100
    s_mul_i32 s101, s44, 9344
    s_waitcnt lgkmcnt(0)
    s_mov_b32 s4, s72
    s_mov_b32 s5, s73
    s_bitcmp1_b32 s48, 0
    s_cselect_b32 s12, s78, s76
    s_cselect_b32 s13, s79, s77
    s_mov_b32 s32, s90
    s_mov_b32 s33, s91
    s_add_u32 m0, s101, 115264
    s_add_u32 s98, s99, 0
    buffer_load_dwordx4 v11, s[4:7], s98 offen lds
    s_add_u32 m0, s101, 116304
    s_add_u32 s98, s99, 1024
    buffer_load_dwordx4 v11, s[4:7], s98 offen lds
    s_add_u32 m0, s101, 117344
    s_add_u32 s98, s99, 2048
    buffer_load_dwordx4 v11, s[4:7], s98 offen lds
    s_add_u32 m0, s101, 118384
    s_add_u32 s98, s99, 3072
    buffer_load_dwordx4 v11, s[4:7], s98 offen lds
    s_add_u32 m0, s101, 123520
    s_add_u32 s98, s100, 0
    buffer_load_dwordx4 v3, s[32:35], s98 offen lds
    s_lshl_b32 s100, s44, 12
    s_add_u32 m0, s101, 119424
    s_add_u32 s98, s100, 0
    buffer_load_dwordx4 v3, s[12:15], s98 offen lds
    s_add_u32 m0, s101, 120448
    s_add_u32 s98, s100, 1024
    buffer_load_dwordx4 v3, s[12:15], s98 offen lds
    s_add_u32 m0, s101, 121472
    s_add_u32 s98, s100, 2048
    buffer_load_dwordx4 v3, s[12:15], s98 offen lds
    s_add_u32 m0, s101, 122496
    s_add_u32 s98, s100, 3072
    buffer_load_dwordx4 v3, s[12:15], s98 offen lds
    s_and_b32 s46, s44, 1
    s_lshl_b32 s46, s46, 1
    s_bfe_u32 s98, s44, 0x10001
    s_add_u32 s46, s46, s98
    s_lshr_b32 s98, s48, 3
    s_sub_u32 s3, s48, s98
    s_and_b32 s99, s48, 7
    s_add_u32 s98, s98, 14
    s_cmp_eq_u32 s99, 7
    s_cselect_b32 s3, s98, s3
    v_lshrrev_b32 v11, 3, v2
    v_and_b32 v12, 7, v2
    v_lshlrev_b32 v12, 4, v12
    v_and_b32 v13, 1, v11
    v_lshlrev_b32 v13, 15, v13
    v_bfe_u32 v14, v11, 1, 1
    v_lshl_add_u32 v13, v14, 14, v13
    v_and_b32 v14, 4, v11
    v_lshl_add_u32 v13, v14, 14, v13
    v_add_u32 v4, v13, v12
    v_and_b32 v13, 16, v2
    v_lshlrev_b32 v13, 2, v13
    v_xor_b32 v12, v12, v13
    v_lshl_add_u32 v6, v11, 10, v12
    v_lshrrev_b32 v11, 4, v2
    v_and_b32 v12, 15, v2
    v_lshlrev_b32 v13, 2, v11
    v_xor_b32 v12, v12, v13
    v_mul_u32_u24 v5, 3584, v11
    v_lshl_add_u32 v5, v12, 4, v5
    s_lshl_b32 s59, s44, 11
    s_lshl_b32 s62, s44, 10
    s_lshl_b32 s52, s47, 17
    s_add_u32 s52, s52, s59
    s_mul_i32 s53, s44, 2080
    s_mul_i32 s54, s44, 28672
    s_lshl_b32 s98, s3, 8
    s_add_u32 s54, s54, s98
    s_lshl_b32 s55, s44, 13
    s_lshr_b32 s98, s48, 1
    s_lshl_b32 s98, s98, 7
    s_add_u32 s55, s55, s98
    s_cmp_ge_u32 s3, 14
    s_cselect_b32 s22, 0, 1835008
    s_mov_b32 s26, s22
    s_and_b32 s63, s47, 3
    s_add_u32 s63, s63, s48
    s_and_b32 s63, s63, 7
    s_mov_b32 s8, s74
    s_mov_b32 s9, s75
    s_mov_b32 s10, 524288
    s_mov_b32 s11, 0x20000
    s_mov_b32 s20, s84
    s_mov_b32 s21, s85
    s_mov_b32 s23, 0x20000
    s_mov_b32 s24, s86
    s_mov_b32 s25, s87
    s_mov_b32 s27, 0x20000
    s_load_dword s49, s[96:97], 139264
    s_mov_b32 s16, s80
    s_mov_b32 s17, s81
    s_mov_b32 s18, 524288
    s_mov_b32 s19, 0x20000
    s_mov_b32 s28, s88
    s_mov_b32 s29, s89
    s_mov_b32 s30, 1835008
    s_mov_b32 s31, 0x20000
    s_mov_b32 s36, s92
    s_mov_b32 s37, s93
    s_mov_b32 s38, 2097152
    s_mov_b32 s39, 0x20000
    s_mov_b32 s40, s96
    s_mov_b32 s41, s97
    s_mov_b32 s42, 10485760
    s_mov_b32 s43, 0x20000
    s_mov_b32 s60, 0xffff
    s_mov_b32 s61, 0xffff
    s_lshl_b32 s67, s47, 4
    s_add_u32 s67, s67, s48
    s_and_b32 s99, s48, 1
    s_lshl_b32 s69, s47, 2
    s_lshl_b32 s99, s99, 1
    s_add_u32 s69, s69, s99
    s_and_b32 s98, s44, 1
    s_add_u32 s69, s69, s98
    s_mul_i32 s68, s69, 147456
    s_add_u32 s68, s68, 1048576
    s_lshl_b32 s98, s47, 2
    s_add_u32 s98, s98, s46
    s_lshl_b32 s99, s48, 1
    s_add_u32 s99, s99, s45
    s_mul_i32 s98, s98, 144
    s_add_u32 s57, s98, s99
    s_lshl_b32 s57, s57, 10
    s_add_u32 s57, s57, 1163264
    s_lshl_b32 s58, s47, 1
    s_and_b32 s99, s44, 1
    s_add_u32 s58, s58, s99
    s_lshl_b32 s58, s58, 4
    s_add_u32 s58, s58, s48
    s_lshl_b32 s58, s58, 2
    s_lshr_b32 s100, s44, 1
    s_add_u32 s58, s58, s100
    s_lshl_b32 s58, s58, 6
    s_add_u32 s58, s58, 327680
    s_lshl_b32 s99, s3, 3
    s_add_u32 s98, s98, s99
    s_lshl_b32 s99, s100, 1
    s_add_u32 s98, s98, s99
    s_lshl_b32 s98, s98, 10
    s_add_u32 s56, s98, 1048576
    s_cmp_ge_u32 s3, 14
    s_cselect_b32 s56, 0x40000000, s56
    s_mov_b32 s3, 0
    s_branch L_init_e
L_init_1:
    s_and_b32 s46, s44, 1
    s_lshl_b32 s46, s46, 1
    s_bfe_u32 s98, s44, 0x10001
    s_add_u32 s46, s46, s98
    s_lshr_b32 s98, s48, 3
    s_sub_u32 s3, s48, s98
    s_and_b32 s99, s48, 7
    s_add_u32 s98, s98, 14
    s_cmp_eq_u32 s99, 7
    s_cselect_b32 s3, s98, s3
    v_lshrrev_b32 v11, 3, v2
    v_and_b32 v12, 7, v2
    v_lshlrev_b32 v12, 4, v12
    v_and_b32 v13, 1, v11
    v_lshlrev_b32 v13, 15, v13
    v_bfe_u32 v14, v11, 1, 1
    v_lshl_add_u32 v13, v14, 14, v13
    v_and_b32 v14, 4, v11
    v_lshl_add_u32 v13, v14, 14, v13
    v_add_u32 v4, v13, v12
    v_and_b32 v13, 16, v2
    v_lshlrev_b32 v13, 2, v13
    v_xor_b32 v12, v12, v13
    v_lshl_add_u32 v6, v11, 10, v12
    v_lshrrev_b32 v11, 4, v2
    v_and_b32 v12, 15, v2
    v_lshlrev_b32 v13, 2, v11
    v_xor_b32 v12, v12, v13
    v_mul_u32_u24 v5, 3584, v11
    v_lshl_add_u32 v5, v12, 4, v5
    s_lshl_b32 s59, s44, 11
    s_lshl_b32 s62, s44, 10
    s_lshl_b32 s52, s47, 17
    s_add_u32 s52, s52, s59
    s_mul_i32 s53, s44, 2080
    s_mul_i32 s54, s44, 28672
    s_lshl_b32 s98, s3, 8
    s_add_u32 s54, s54, s98
    s_lshl_b32 s55, s44, 13
    s_lshr_b32 s98, s48, 1
    s_lshl_b32 s98, s98, 7
    s_add_u32 s55, s55, s98
    s_cmp_ge_u32 s3, 14
    s_cselect_b32 s22, 0, 1835008
    s_mov_b32 s26, s22
    s_and_b32 s63, s47, 3
    s_add_u32 s63, s63, s48
    s_and_b32 s63, s63, 7
    s_waitcnt lgkmcnt(0)
    s_mov_b32 s4, s72
    s_mov_b32 s5, s73
    s_bitcmp1_b32 s48, 0
    s_cselect_b32 s12, s78, s76
    s_cselect_b32 s13, s79, s77
    s_mov_b32 s32, s90
    s_mov_b32 s33, s91
    s_mov_b32 s8, s74
    s_mov_b32 s9, s75
    s_mov_b32 s10, 524288
    s_mov_b32 s11, 0x20000
    s_mov_b32 s20, s84
    s_mov_b32 s21, s85
    s_mov_b32 s23, 0x20000
    s_mov_b32 s24, s86
    s_mov_b32 s25, s87
    s_mov_b32 s27, 0x20000
    s_load_dword s49, s[96:97], 139264
    s_mov_b32 s16, s80
    s_mov_b32 s17, s81
    s_mov_b32 s18, 524288
    s_mov_b32 s19, 0x20000
    s_mov_b32 s28, s88
    s_mov_b32 s29, s89
    s_mov_b32 s30, 1835008
    s_mov_b32 s31, 0x20000
    s_mov_b32 s36, s92
    s_mov_b32 s37, s93
    s_mov_b32 s38, 2097152
    s_mov_b32 s39, 0x20000
    s_mov_b32 s40, s96
    s_mov_b32 s41, s97
    s_mov_b32 s42, 10485760
    s_mov_b32 s43, 0x20000
    s_mov_b32 s60, 0xffff
    s_mov_b32 s61, 0xffff
    s_lshl_b32 s67, s47, 4
    s_add_u32 s67, s67, s48
    s_and_b32 s99, s48, 1
    s_lshl_b32 s69, s47, 2
    s_lshl_b32 s99, s99, 1
    s_add_u32 s69, s69, s99
    s_and_b32 s98, s44, 1
    s_add_u32 s69, s69, s98
    s_mul_i32 s68, s69, 147456
    s_add_u32 s68, s68, 1048576
    s_lshl_b32 s98, s47, 2
    s_add_u32 s98, s98, s46
    s_lshl_b32 s99, s48, 1
    s_add_u32 s99, s99, s45
    s_mul_i32 s98, s98, 144
    s_add_u32 s57, s98, s99
    s_lshl_b32 s57, s57, 10
    s_add_u32 s57, s57, 1163264
    s_lshl_b32 s58, s47, 1
    s_and_b32 s99, s44, 1
    s_add_u32 s58, s58, s99
    s_lshl_b32 s58, s58, 4
    s_add_u32 s58, s58, s48
    s_lshl_b32 s58, s58, 2
    s_lshr_b32 s100, s44, 1
    s_add_u32 s58, s58, s100
    s_lshl_b32 s58, s58, 6
    s_add_u32 s58, s58, 327680
    s_lshl_b32 s99, s3, 3
    s_add_u32 s98, s98, s99
    s_lshl_b32 s99, s100, 1
    s_add_u32 s98, s98, s99
    s_lshl_b32 s98, s98, 10
    s_add_u32 s56, s98, 1048576
    s_cmp_ge_u32 s3, 14
    s_cselect_b32 s56, 0x40000000, s56
    s_mov_b32 s3, 0
    s_mov_b32 s99, 0
    s_lshl_b32 s64, s99, 7
    s_add_u32 s64, s64, s52
    s_add_u32 m0, s53, -8320
    s_add_u32 s98, s64, -8192
    buffer_load_dwordx4 v4, s[4:7], s98 offen lds
    s_add_u32 m0, s53, -7280
    s_add_u32 s98, s64, -7168
    buffer_load_dwordx4 v4, s[4:7], s98 offen lds
    s_add_u32 m0, s53, 0
    s_add_u32 s98, s64, 0
    buffer_load_dwordx4 v4, s[4:7], s98 offen lds
    s_add_u32 m0, s53, 1040
    s_add_u32 s98, s64, 1024
    buffer_load_dwordx4 v4, s[4:7], s98 offen lds
    s_mov_b32 s99, 0
    s_mul_i32 s65, s99, 229376
    s_add_u32 s65, s65, s54
    s_lshl_b32 s66, s99, 16
    s_add_u32 s66, s66, s55
    s_add_u32 m0, s59, 25088
    s_add_u32 s98, s65, -114688
    buffer_load_dwordx4 v5, s[20:23], s98 offen lds
    s_add_u32 m0, s59, 41504
    s_add_u32 s98, s65, -114688
    buffer_load_dwordx4 v5, s[24:27], s98 offen lds
    s_add_u32 m0, s59, 26112
    s_add_u32 s98, s65, -100352
    buffer_load_dwordx4 v5, s[20:23], s98 offen lds
    s_add_u32 m0, s59, 42528
    s_add_u32 s98, s65, -100352
    buffer_load_dwordx4 v5, s[24:27], s98 offen lds
    s_add_u32 m0, s62, 61984
    s_add_u32 s98, s66, -32768
    buffer_load_dwordx4 v6, s[8:11], s98 offen lds
    s_add_u32 m0, s59, 33280
    s_add_u32 s98, s65, 0
    buffer_load_dwordx4 v5, s[20:23], s98 offen lds
    s_add_u32 m0, s59, 49696
    s_add_u32 s98, s65, 0
    buffer_load_dwordx4 v5, s[24:27], s98 offen lds
    s_add_u32 m0, s59, 34304
    s_add_u32 s98, s65, 14336
    buffer_load_dwordx4 v5, s[20:23], s98 offen lds
    s_add_u32 m0, s59, 50720
    s_add_u32 s98, s65, 14336
    buffer_load_dwordx4 v5, s[24:27], s98 offen lds
    s_add_u32 m0, s62, 66080
    s_add_u32 s98, s66, 0
    buffer_load_dwordx4 v6, s[8:11], s98 offen lds
    s_add_u32 s99, s63, 0
    s_and_b32 s99, s99, 1
    s_add_u32 s99, s99, 1
    s_lshl_b32 s64, s99, 7
    s_add_u32 s64, s64, s52
    s_add_u32 m0, s53, 8320
    s_add_u32 s98, s64, -8192
    buffer_load_dwordx4 v4, s[4:7], s98 offen lds
    s_add_u32 m0, s53, 9360
    s_add_u32 s98, s64, -7168
    buffer_load_dwordx4 v4, s[4:7], s98 offen lds
    s_add_u32 m0, s53, 16640
    s_add_u32 s98, s64, 0
    buffer_load_dwordx4 v4, s[4:7], s98 offen lds
    s_add_u32 m0, s53, 17680
    s_add_u32 s98, s64, 1024
    buffer_load_dwordx4 v4, s[4:7], s98 offen lds
    s_add_u32 s99, s63, 0
    s_and_b32 s99, s99, 1
    s_add_u32 s99, s99, 1
    s_mul_i32 s65, s99, 229376
    s_add_u32 s65, s65, s54
    s_lshl_b32 s66, s99, 16
    s_add_u32 s66, s66, s55
    s_add_u32 m0, s59, 66080
    s_add_u32 s98, s65, -114688
    buffer_load_dwordx4 v5, s[20:23], s98 offen lds
    s_add_u32 m0, s59, 82496
    s_add_u32 s98, s65, -114688
    buffer_load_dwordx4 v5, s[24:27], s98 offen lds
    s_add_u32 m0, s59, 67104
    s_add_u32 s98, s65, -100352
    buffer_load_dwordx4 v5, s[20:23], s98 offen lds
    s_add_u32 m0, s59, 83520
    s_add_u32 s98, s65, -100352
    buffer_load_dwordx4 v5, s[24:27], s98 offen lds
    s_add_u32 m0, s62, 102976
    s_add_u32 s98, s66, -32768
    buffer_load_dwordx4 v6, s[8:11], s98 offen lds
    s_add_u32 m0, s59, 74272
    s_add_u32 s98, s65, 0
    buffer_load_dwordx4 v5, s[20:23], s98 offen lds
    s_add_u32 m0, s59, 90688
    s_add_u32 s98, s65, 0
    buffer_load_dwordx4 v5, s[24:27], s98 offen lds
    s_add_u32 m0, s59, 75296
    s_add_u32 s98, s65, 14336
    buffer_load_dwordx4 v5, s[20:23], s98 offen lds
    s_add_u32 m0, s59, 91712
    s_add_u32 s98, s65, 14336
    buffer_load_dwordx4 v5, s[24:27], s98 offen lds
    s_add_u32 m0, s62, 107072
    s_add_u32 s98, s66, 0
    buffer_load_dwordx4 v6, s[8:11], s98 offen lds
L_init_e:
    v_and_b32 v11, 15, v2
    v_mul_u32_u24 v7, 1040, v11
    v_bfe_u32 v11, v2, 4, 1
    v_lshl_add_u32 v7, v11, 8, v7
    v_lshrrev_b32 v12, 5, v2
    v_lshl_add_u32 v7, v12, 4, v7
    s_and_b32 s99, s46, 1
    s_lshl_b32 s99, s99, 7
    s_lshr_b32 s100, s46, 1
    s_lshl_b32 s100, s100, 9
    s_add_u32 s99, s99, s100
    s_lshl_b32 s100, s45, 6
    s_xor_b32 s98, s99, 128
    s_sub_u32 s101, s98, s100
    v_add_u32 v0, s101, v7
    s_add_u32 s101, s98, s100
    v_add_u32 v15, s101, v7
    s_sub_u32 s101, s99, s100
    s_add_u32 s99, s99, s100
    v_add_u32 v8, s101, v7
    v_add_u32 v7, s99, v7
    v_bfe_u32 v13, v2, 2, 2
    v_lshl_add_u32 v12, v12, 3, v13
    s_lshr_b32 s98, s44, 1
    v_xor_b32 v14, s98, v13
    v_lshlrev_b32 v9, 6, v14
    v_lshl_add_u32 v9, v12, 8, v9
    v_and_b32 v13, 3, v2
    v_lshl_add_u32 v9, v13, 3, v9
    v_mul_u32_u24 v14, 16416, v11
    v_add_u32 v9, v9, v14
    s_lshl_b32 s100, s45, 13
    s_sub_u32 s101, 33280, s100
    s_add_u32 s99, s100, 33280
    v_add_u32 v10, s101, v9
    v_add_u32 v9, s99, v9
    v_lshlrev_b32 v1, 7, v12
    v_lshl_add_u32 v1, v13, 3, v1
    v_lshl_add_u32 v1, v11, 5, v1
    v_bfe_u32 v13, v2, 3, 1
    s_and_b32 s99, s48, 1
    v_xor_b32 v14, s99, v13
    v_lshl_add_u32 v1, v14, 6, v1
    s_lshl_b32 s100, s45, 12
    s_add_u32 s99, s100, 66080
    v_add_u32 v1, s99, v1
    s_waitcnt lgkmcnt(0)
    s_sub_u32 s96, s45, 1
    s_mov_b32 s97, s96
    s_mul_i32 s49, s49, 0x9E3779B1
    s_add_u32 s49, s49, 0x7F4A7C15
    s_mov_b32 s50, 3222493025
    s_mov_b32 s51, 3184710632
    s_cmp_eq_u32 s45, 0
    s_cbranch_scc1 L_quick
L_quick_done:
    s_cmp_eq_u32 s22, 0
    s_cbranch_scc1 L_spare
    s_waitcnt vmcnt(14) lgkmcnt(0)
    s_barrier
    s_cmp_lt_u32 s44, 3
    s_cbranch_scc1 L_qfin
L_qfin_r:
    ds_read_b128 v[128:131], v7 offset:0
    ds_read_b64_tr_b16 v[96:97], v9 offset:0
    ds_read_b64_tr_b16 v[98:99], v9 offset:1024
    ds_read_b64_tr_b16 v[100:101], v9 offset:32
    ds_read_b64_tr_b16 v[102:103], v9 offset:1056
    ds_read_b128 v[132:135], v15 offset:0
    ds_read_b64_tr_b16 v[120:121], v1 offset:0
    ds_read_b64_tr_b16 v[122:123], v1 offset:512
    ds_read_b128 v[136:139], v7 offset:32
    ds_read_b64_tr_b16 v[104:105], v9 offset:4096
    ds_read_b64_tr_b16 v[106:107], v9 offset:5120
    ds_read_b64_tr_b16 v[108:109], v9 offset:4128
    ds_read_b64_tr_b16 v[110:111], v9 offset:5152
    ds_read_b128 v[140:143], v15 offset:32
    s_waitcnt lgkmcnt(13)
    ds_read_b64_tr_b16 v[124:125], v1 offset:2048
    ds_read_b64_tr_b16 v[126:127], v1 offset:2560
    s_barrier
    s_waitcnt lgkmcnt(8)
    v_mfma_f32_32x32x16_bf16 v[80:95], v[120:123], v[128:131], 0
    ds_read_b128 v[144:147], v8 offset:64
    ds_read_b64_tr_b16 v[112:113], v10 offset:8192
    ds_read_b64_tr_b16 v[114:115], v10 offset:9216
    s_add_u32 s99, s63, 1
    s_and_b32 s99, s99, 1
    s_add_u32 s99, s99, 1
    s_mul_i32 s65, s99, 229376
    s_add_u32 s65, s65, s54
    s_lshl_b32 s66, s99, 16
    s_add_u32 s66, s66, s55
    s_add_u32 m0, s59, 115264
    s_add_u32 s98, s65, 0
    buffer_load_dwordx4 v5, s[20:23], s98 offen lds
    v_mfma_f32_32x32x16_bf16 v[16:31], v[96:99], v[128:131], 0
    ds_read_b64_tr_b16 v[116:117], v10 offset:8224
    ds_read_b64_tr_b16 v[118:119], v10 offset:9248
    s_add_u32 m0, s59, 131680
    s_add_u32 s98, s65, 0
    buffer_load_dwordx4 v5, s[24:27], s98 offen lds
    v_mfma_f32_32x32x16_bf16 v[32:47], v[100:103], v[128:131], 0
    ds_read_b128 v[148:151], v0 offset:64
    v_mfma_f32_32x32x16_bf16 v[48:63], v[96:99], v[132:135], 0
    s_add_u32 m0, s59, 116288
    s_add_u32 s98, s65, 14336
    buffer_load_dwordx4 v5, s[20:23], s98 offen lds
    v_mfma_f32_32x32x16_bf16 v[64:79], v[100:103], v[132:135], 0
    s_waitcnt lgkmcnt(6)
    v_mfma_f32_32x32x16_bf16 v[80:95], v[124:127], v[136:139], v[80:95]
    ds_read_b128 v[128:131], v8 offset:96
    ds_read_b64_tr_b16 v[96:97], v10 offset:12288
    ds_read_b64_tr_b16 v[98:99], v10 offset:13312
    s_add_u32 m0, s59, 132704
    s_add_u32 s98, s65, 14336
    buffer_load_dwordx4 v5, s[24:27], s98 offen lds
    v_mfma_f32_32x32x16_bf16 v[16:31], v[104:107], v[136:139], v[16:31]
    ds_read_b64_tr_b16 v[100:101], v10 offset:12320
    ds_read_b64_tr_b16 v[102:103], v10 offset:13344
    v_mfma_f32_32x32x16_bf16 v[32:47], v[108:111], v[136:139], v[32:47]
    ds_read_b128 v[132:135], v0 offset:96
    s_add_u32 m0, s62, 148064
    s_add_u32 s98, s66, 0
    buffer_load_dwordx4 v6, s[8:11], s98 offen lds
    v_mfma_f32_32x32x16_bf16 v[48:63], v[104:107], v[140:143], v[48:63]
    v_mfma_f32_32x32x16_bf16 v[64:79], v[108:111], v[140:143], v[64:79]
    s_waitcnt vmcnt(5) lgkmcnt(0)
    s_barrier
    s_cmp_eq_u32 s44, 2
    s_cbranch_scc1 L_kvf
L_kvf_r:
    v_mfma_f32_32x32x16_bf16 v[16:31], v[112:115], v[144:147], v[16:31]
    ds_read_b128 v[136:139], v7 offset:16640
    ds_read_b64_tr_b16 v[104:105], v9 offset:40992
    ds_read_b64_tr_b16 v[106:107], v9 offset:42016
    s_add_u32 s99, s63, 1
    s_and_b32 s99, s99, 1
    s_add_u32 s99, s99, 1
    s_lshl_b32 s64, s99, 7
    s_add_u32 s64, s64, s52
    s_add_u32 m0, s53, 0
    s_add_u32 s98, s64, 0
    buffer_load_dwordx4 v4, s[4:7], s98 offen lds
    v_add_u32 v192, 81984, v9
    v_add_u32 v193, 81984, v10
    v_mfma_f32_32x32x16_bf16 v[32:47], v[116:119], v[144:147], v[32:47]
    ds_read_b64_tr_b16 v[108:109], v9 offset:41024
    ds_read_b64_tr_b16 v[110:111], v9 offset:42048
    v_add_u32 v194, 81984, v1
    v_mfma_f32_32x32x16_bf16 v[48:63], v[112:115], v[148:151], v[48:63]
    ds_read_b128 v[140:143], v15 offset:16640
    s_add_u32 m0, s53, 1040
    s_add_u32 s98, s64, 1024
    buffer_load_dwordx4 v4, s[4:7], s98 offen lds
    v_mfma_f32_32x32x16_bf16 v[64:79], v[116:119], v[148:151], v[64:79]
    ds_read_b64_tr_b16 v[120:121], v1 offset:40992
    ds_read_b64_tr_b16 v[122:123], v1 offset:41504
    v_mfma_f32_32x32x16_bf16 v[16:31], v[96:99], v[128:131], v[16:31]
    ds_read_b128 v[144:147], v7 offset:16672
    ds_read_b64_tr_b16 v[112:113], v9 offset:45088
    ds_read_b64_tr_b16 v[114:115], v9 offset:46112
    s_add_u32 s99, s63, 0
    s_and_b32 s99, s99, 1
    s_add_u32 s99, s99, 3
    s_mul_i32 s65, s99, 229376
    s_add_u32 s65, s65, s54
    s_lshl_b32 s66, s99, 16
    s_add_u32 s66, s66, s55
    s_add_u32 m0, s59, 33280
    s_add_u32 s98, s65, 0
    buffer_load_dwordx4 v5, s[20:23], s98 offen lds
    v_mfma_f32_32x32x16_bf16 v[32:47], v[100:103], v[128:131], v[32:47]
    ds_read_b64_tr_b16 v[116:117], v9 offset:45120
    ds_read_b64_tr_b16 v[118:119], v9 offset:46144
    v_mfma_f32_32x32x16_bf16 v[48:63], v[96:99], v[132:135], v[48:63]
    ds_read_b128 v[148:151], v15 offset:16672
    s_add_u32 m0, s59, 49696
    s_add_u32 s98, s65, 0
    buffer_load_dwordx4 v5, s[24:27], s98 offen lds
    v_mfma_f32_32x32x16_bf16 v[64:79], v[100:103], v[132:135], v[64:79]
    s_waitcnt lgkmcnt(13)
    ds_read_b64_tr_b16 v[124:125], v1 offset:43040
    ds_read_b64_tr_b16 v[126:127], v1 offset:43552
    s_waitcnt lgkmcnt(8)
    v_mfma_f32_32x32x16_bf16 v[80:95], v[120:123], v[136:139], v[80:95]
    ds_read_b128 v[128:131], v8 offset:16704
    ds_read_b64_tr_b16 v[96:97], v10 offset:49184
    ds_read_b64_tr_b16 v[98:99], v10 offset:50208
    v_mfma_f32_32x32x16_bf16 v[16:31], v[104:107], v[136:139], v[16:31]
    ds_read_b64_tr_b16 v[100:101], v10 offset:49216
    ds_read_b64_tr_b16 v[102:103], v10 offset:50240
    s_add_u32 m0, s59, 34304
    s_add_u32 s98, s65, 14336
    buffer_load_dwordx4 v5, s[20:23], s98 offen lds
    v_mfma_f32_32x32x16_bf16 v[32:47], v[108:111], v[136:139], v[32:47]
    ds_read_b128 v[132:135], v0 offset:16704
    v_mfma_f32_32x32x16_bf16 v[48:63], v[104:107], v[140:143], v[48:63]
    s_add_u32 m0, s59, 50720
    s_add_u32 s98, s65, 14336
    buffer_load_dwordx4 v5, s[24:27], s98 offen lds
    v_mfma_f32_32x32x16_bf16 v[64:79], v[108:111], v[140:143], v[64:79]
    s_waitcnt lgkmcnt(6)
    v_mfma_f32_32x32x16_bf16 v[80:95], v[124:127], v[144:147], v[80:95]
    ds_read_b128 v[136:139], v8 offset:16736
    ds_read_b64_tr_b16 v[104:105], v10 offset:53280
    ds_read_b64_tr_b16 v[106:107], v10 offset:54304
    s_add_u32 m0, s62, 66080
    s_add_u32 s98, s66, 0
    buffer_load_dwordx4 v6, s[8:11], s98 offen lds
    v_mfma_f32_32x32x16_bf16 v[16:31], v[112:115], v[144:147], v[16:31]
    ds_read_b64_tr_b16 v[108:109], v10 offset:53312
    ds_read_b64_tr_b16 v[110:111], v10 offset:54336
    v_mfma_f32_32x32x16_bf16 v[32:47], v[116:119], v[144:147], v[32:47]
    ds_read_b128 v[140:143], v0 offset:16736
    v_mfma_f32_32x32x16_bf16 v[48:63], v[112:115], v[148:151], v[48:63]
    v_mfma_f32_32x32x16_bf16 v[64:79], v[116:119], v[148:151], v[64:79]
    s_waitcnt vmcnt(5) lgkmcnt(0)
    s_barrier
    v_mfma_f32_32x32x16_bf16 v[16:31], v[96:99], v[128:131], v[16:31]
    ds_read_b128 v[144:147], v7 offset:0
    ds_read_b64_tr_b16 v[112:113], v192 offset:0
    ds_read_b64_tr_b16 v[114:115], v192 offset:1024
    s_add_u32 s99, s63, 0
    s_and_b32 s99, s99, 1
    s_add_u32 s99, s99, 3
    s_lshl_b32 s64, s99, 7
    s_add_u32 s64, s64, s52
    s_add_u32 m0, s53, 16640
    s_add_u32 s98, s64, 0
    buffer_load_dwordx4 v4, s[4:7], s98 offen lds
    v_mfma_f32_32x32x16_bf16 v[32:47], v[100:103], v[128:131], v[32:47]
    ds_read_b64_tr_b16 v[116:117], v192 offset:32
    ds_read_b64_tr_b16 v[118:119], v192 offset:1056
    v_mfma_f32_32x32x16_bf16 v[48:63], v[96:99], v[132:135], v[48:63]
    ds_read_b128 v[148:151], v15 offset:0
    s_add_u32 m0, s53, 17680
    s_add_u32 s98, s64, 1024
    buffer_load_dwordx4 v4, s[4:7], s98 offen lds
    v_mfma_f32_32x32x16_bf16 v[64:79], v[100:103], v[132:135], v[64:79]
    ds_read_b64_tr_b16 v[120:121], v194 offset:0
    ds_read_b64_tr_b16 v[122:123], v194 offset:512
    v_mfma_f32_32x32x16_bf16 v[16:31], v[104:107], v[136:139], v[16:31]
    ds_read_b128 v[128:131], v7 offset:32
    ds_read_b64_tr_b16 v[96:97], v192 offset:4096
    ds_read_b64_tr_b16 v[98:99], v192 offset:5120
    s_add_u32 s99, s63, 1
    s_and_b32 s99, s99, 1
    s_add_u32 s99, s99, 3
    s_mul_i32 s65, s99, 229376
    s_add_u32 s65, s65, s54
    s_lshl_b32 s66, s99, 16
    s_add_u32 s66, s66, s55
    s_add_u32 m0, s59, 74272
    s_add_u32 s98, s65, 0
    buffer_load_dwordx4 v5, s[20:23], s98 offen lds
    v_mfma_f32_32x32x16_bf16 v[32:47], v[108:111], v[136:139], v[32:47]
    ds_read_b64_tr_b16 v[100:101], v192 offset:4128
    ds_read_b64_tr_b16 v[102:103], v192 offset:5152
    v_mfma_f32_32x32x16_bf16 v[48:63], v[104:107], v[140:143], v[48:63]
    ds_read_b128 v[132:135], v15 offset:32
    s_add_u32 m0, s59, 90688
    s_add_u32 s98, s65, 0
    buffer_load_dwordx4 v5, s[24:27], s98 offen lds
    v_mfma_f32_32x32x16_bf16 v[64:79], v[108:111], v[140:143], v[64:79]
    s_waitcnt lgkmcnt(13)
    ds_read_b64_tr_b16 v[124:125], v194 offset:2048
    ds_read_b64_tr_b16 v[126:127], v194 offset:2560
    s_waitcnt lgkmcnt(8)
    v_mfma_f32_32x32x16_bf16 v[80:95], v[120:123], v[144:147], v[80:95]
    ds_read_b128 v[136:139], v8 offset:64
    ds_read_b64_tr_b16 v[104:105], v193 offset:8192
    ds_read_b64_tr_b16 v[106:107], v193 offset:9216
    v_mfma_f32_32x32x16_bf16 v[16:31], v[112:115], v[144:147], v[16:31]
    ds_read_b64_tr_b16 v[108:109], v193 offset:8224
    ds_read_b64_tr_b16 v[110:111], v193 offset:9248
    s_add_u32 m0, s59, 75296
    s_add_u32 s98, s65, 14336
    buffer_load_dwordx4 v5, s[20:23], s98 offen lds
    v_mfma_f32_32x32x16_bf16 v[32:47], v[116:119], v[144:147], v[32:47]
    ds_read_b128 v[140:143], v0 offset:64
    v_mfma_f32_32x32x16_bf16 v[48:63], v[112:115], v[148:151], v[48:63]
    s_add_u32 m0, s59, 91712
    s_add_u32 s98, s65, 14336
    buffer_load_dwordx4 v5, s[24:27], s98 offen lds
    v_mfma_f32_32x32x16_bf16 v[64:79], v[116:119], v[148:151], v[64:79]
    s_waitcnt lgkmcnt(6)
    v_mfma_f32_32x32x16_bf16 v[80:95], v[124:127], v[128:131], v[80:95]
    ds_read_b128 v[144:147], v8 offset:96
    ds_read_b64_tr_b16 v[112:113], v193 offset:12288
    ds_read_b64_tr_b16 v[114:115], v193 offset:13312
    s_add_u32 m0, s62, 107072
    s_add_u32 s98, s66, 0
    buffer_load_dwordx4 v6, s[8:11], s98 offen lds
    v_mfma_f32_32x32x16_bf16 v[16:31], v[96:99], v[128:131], v[16:31]
    ds_read_b64_tr_b16 v[116:117], v193 offset:12320
    ds_read_b64_tr_b16 v[118:119], v193 offset:13344
    v_mfma_f32_32x32x16_bf16 v[32:47], v[100:103], v[128:131], v[32:47]
    ds_read_b128 v[148:151], v0 offset:96
    v_mfma_f32_32x32x16_bf16 v[48:63], v[96:99], v[132:135], v[48:63]
    v_mfma_f32_32x32x16_bf16 v[64:79], v[100:103], v[132:135], v[64:79]
    s_waitcnt vmcnt(5) lgkmcnt(0)
    s_barrier
    v_mfma_f32_32x32x16_bf16 v[16:31], v[104:107], v[136:139], v[16:31]
    ds_read_b128 v[128:131], v7 offset:16640
    ds_read_b64_tr_b16 v[96:97], v9 offset:0
    ds_read_b64_tr_b16 v[98:99], v9 offset:1024
    s_add_u32 s99, s63, 1
    s_and_b32 s99, s99, 1
    s_add_u32 s99, s99, 3
    s_lshl_b32 s64, s99, 7
    s_add_u32 s64, s64, s52
    s_add_u32 m0, s53, 0
    s_add_u32 s98, s64, 0
    buffer_load_dwordx4 v4, s[4:7], s98 offen lds
    v_and_b32 v12, 27, v2
    v_cmp_eq_u32 vcc, 16, v12
    v_mov_b32 v12, 0x3f803f80
    s_nop 0
    v_cndmask_b32 v176, 0, v12, vcc
    v_mov_b32 v177, v176
    v_mfma_f32_32x32x16_bf16 v[32:47], v[108:111], v[136:139], v[32:47]
    ds_read_b64_tr_b16 v[100:101], v9 offset:32
    ds_read_b64_tr_b16 v[102:103], v9 offset:1056
    v_mov_b64 v[178:179], v[176:177]
    v_mov_b64 v[180:181], v[176:177]
    v_mfma_f32_32x32x16_bf16 v[48:63], v[104:107], v[140:143], v[48:63]
    ds_read_b128 v[132:135], v15 offset:16640
    s_add_u32 m0, s53, 1040
    s_add_u32 s98, s64, 1024
    buffer_load_dwordx4 v4, s[4:7], s98 offen lds
    v_mov_b64 v[182:183], v[176:177]
    v_mov_b64 v[184:185], v[176:177]
    v_mfma_f32_32x32x16_bf16 v[64:79], v[108:111], v[140:143], v[64:79]
    ds_read_b64_tr_b16 v[120:121], v1 offset:0
    ds_read_b64_tr_b16 v[122:123], v1 offset:512
    v_mov_b64 v[186:187], v[176:177]
    v_mov_b64 v[188:189], v[176:177]
    v_mfma_f32_32x32x16_bf16 v[16:31], v[112:115], v[144:147], v[16:31]
    ds_read_b128 v[136:139], v7 offset:16672
    ds_read_b64_tr_b16 v[104:105], v9 offset:4096
    ds_read_b64_tr_b16 v[106:107], v9 offset:5120
    s_add_u32 s99, s63, 0
    s_mul_i32 s98, s99, 21846
    s_lshr_b32 s98, s98, 16
    s_mul_i32 s98, s98, 3
    s_sub_u32 s99, s99, s98
    s_add_u32 s99, s99, 5
    s_mul_i32 s65, s99, 229376
    s_add_u32 s65, s65, s54
    s_lshl_b32 s66, s99, 16
    s_add_u32 s66, s66, s55
    s_add_u32 m0, s59, 115264
    s_add_u32 s98, s65, 0
    buffer_load_dwordx4 v5, s[20:23], s98 offen lds
    v_mov_b64 v[190:191], v[176:177]
    v_mov_b64 v[160:161], 0
    v_mfma_f32_32x32x16_bf16 v[32:47], v[116:119], v[144:147], v[32:47]
    ds_read_b64_tr_b16 v[108:109], v9 offset:4128
    ds_read_b64_tr_b16 v[110:111], v9 offset:5152
    v_mov_b64 v[162:163], 0
    v_mov_b64 v[164:165], 0
    v_mfma_f32_32x32x16_bf16 v[48:63], v[112:115], v[148:151], v[48:63]
    ds_read_b128 v[140:143], v15 offset:16672
    s_add_u32 m0, s59, 131680
    s_add_u32 s98, s65, 0
    buffer_load_dwordx4 v5, s[24:27], s98 offen lds
    v_mov_b64 v[166:167], 0
    v_mov_b64 v[168:169], 0
    v_mfma_f32_32x32x16_bf16 v[64:79], v[116:119], v[148:151], v[64:79]
    s_waitcnt lgkmcnt(13)
    ds_read_b64_tr_b16 v[124:125], v1 offset:2048
    ds_read_b64_tr_b16 v[126:127], v1 offset:2560
    v_mov_b64 v[170:171], 0
    v_mov_b64 v[172:173], 0
    s_waitcnt lgkmcnt(8)
    v_mfma_f32_32x32x16_bf16 v[80:95], v[120:123], v[128:131], v[80:95]
    ds_read_b128 v[144:147], v8 offset:16704
    ds_read_b64_tr_b16 v[112:113], v10 offset:8192
    ds_read_b64_tr_b16 v[114:115], v10 offset:9216
    v_mov_b64 v[174:175], 0
    v_mov_b64 v[200:201], 0
    v_mfma_f32_32x32x16_bf16 v[16:31], v[96:99], v[128:131], v[16:31]
    ds_read_b64_tr_b16 v[116:117], v10 offset:8224
    ds_read_b64_tr_b16 v[118:119], v10 offset:9248
    s_add_u32 m0, s59, 116288
    s_add_u32 s98, s65, 14336
    buffer_load_dwordx4 v5, s[20:23], s98 offen lds
    v_mov_b64 v[202:203], 0
    v_mov_b64 v[204:205], 0
    v_mfma_f32_32x32x16_bf16 v[32:47], v[100:103], v[128:131], v[32:47]
    ds_read_b128 v[148:151], v0 offset:16704
    v_mov_b64 v[206:207], 0
    v_mov_b64 v[208:209], 0
    v_mfma_f32_32x32x16_bf16 v[48:63], v[96:99], v[132:135], v[48:63]
    s_add_u32 m0, s59, 132704
    s_add_u32 s98, s65, 14336
    buffer_load_dwordx4 v5, s[24:27], s98 offen lds
    v_mov_b64 v[210:211], 0
    v_mov_b64 v[212:213], 0
    v_mfma_f32_32x32x16_bf16 v[64:79], v[100:103], v[132:135], v[64:79]
    v_mov_b64 v[214:215], 0
    v_mov_b32 v232, s50
    s_waitcnt lgkmcnt(6)
    v_mfma_f32_32x32x16_bf16 v[80:95], v[124:127], v[136:139], v[80:95]
    ds_read_b128 v[128:131], v8 offset:16736
    ds_read_b64_tr_b16 v[96:97], v10 offset:12288
    ds_read_b64_tr_b16 v[98:99], v10 offset:13312
    s_add_u32 m0, s62, 148064
    s_add_u32 s98, s66, 0
    buffer_load_dwordx4 v6, s[8:11], s98 offen lds
    v_mov_b32 v233, s50
    v_mov_b32 v234, s51
    v_mfma_f32_32x32x16_bf16 v[16:31], v[104:107], v[136:139], v[16:31]
    ds_read_b64_tr_b16 v[100:101], v10 offset:12320
    ds_read_b64_tr_b16 v[102:103], v10 offset:13344
    v_mov_b32 v235, s51
    v_mfma_f32_32x32x16_bf16 v[32:47], v[108:111], v[136:139], v[32:47]
    ds_read_b128 v[132:135], v0 offset:16736
    v_mfma_f32_32x32x16_bf16 v[48:63], v[104:107], v[140:143], v[48:63]
    v_mfma_f32_32x32x16_bf16 v[64:79], v[108:111], v[140:143], v[64:79]
    s_waitcnt vmcnt(5) lgkmcnt(0)
    s_barrier
    v_mfma_f32_32x32x16_bf16 v[16:31], v[112:115], v[144:147], v[16:31]
    ds_read_b128 v[136:139], v7 offset:0
    ds_read_b64_tr_b16 v[104:105], v9 offset:40992
    ds_read_b64_tr_b16 v[106:107], v9 offset:42016
    s_add_u32 s99, s63, 0
    s_mul_i32 s98, s99, 21846
    s_lshr_b32 s98, s98, 16
    s_mul_i32 s98, s98, 3
    s_sub_u32 s99, s99, s98
    s_add_u32 s99, s99, 5
    s_lshl_b32 s64, s99, 7
    s_add_u32 s64, s64, s52
    s_add_u32 m0, s53, 16640
    s_add_u32 s98, s64, 0
    buffer_load_dwordx4 v4, s[4:7], s98 offen lds
    v_mfma_f32_32x32x16_bf16 v[32:47], v[116:119], v[144:147], v[32:47]
    ds_read_b64_tr_b16 v[108:109], v9 offset:41024
    ds_read_b64_tr_b16 v[110:111], v9 offset:42048
    v_mfma_f32_32x32x16_bf16 v[48:63], v[112:115], v[148:151], v[48:63]
    ds_read_b128 v[140:143], v15 offset:0
    s_add_u32 m0, s53, 17680
    s_add_u32 s98, s64, 1024
    buffer_load_dwordx4 v4, s[4:7], s98 offen lds
    v_mfma_f32_32x32x16_bf16 v[64:79], v[116:119], v[148:151], v[64:79]
    ds_read_b64_tr_b16 v[120:121], v1 offset:40992
    ds_read_b64_tr_b16 v[122:123], v1 offset:41504
    v_mfma_f32_32x32x16_bf16 v[16:31], v[96:99], v[128:131], v[16:31]
    ds_read_b128 v[144:147], v7 offset:32
    ds_read_b64_tr_b16 v[112:113], v9 offset:45088
    ds_read_b64_tr_b16 v[114:115], v9 offset:46112
    s_add_u32 s99, s63, 1
    s_mul_i32 s98, s99, 21846
    s_lshr_b32 s98, s98, 16
    s_mul_i32 s98, s98, 3
    s_sub_u32 s99, s99, s98
    s_add_u32 s99, s99, 5
    s_mul_i32 s65, s99, 229376
    s_add_u32 s65, s65, s54
    s_lshl_b32 s66, s99, 16
    s_add_u32 s66, s66, s55
    s_add_u32 m0, s59, 33280
    s_add_u32 s98, s65, 0
    buffer_load_dwordx4 v5, s[20:23], s98 offen lds
    v_mfma_f32_32x32x16_bf16 v[32:47], v[100:103], v[128:131], v[32:47]
    ds_read_b64_tr_b16 v[116:117], v9 offset:45120
    ds_read_b64_tr_b16 v[118:119], v9 offset:46144
    v_mfma_f32_32x32x16_bf16 v[48:63], v[96:99], v[132:135], v[48:63]
    ds_read_b128 v[148:151], v15 offset:32
    s_add_u32 m0, s59, 49696
    s_add_u32 s98, s65, 0
    buffer_load_dwordx4 v5, s[24:27], s98 offen lds
    v_mfma_f32_32x32x16_bf16 v[64:79], v[100:103], v[132:135], v[64:79]
    s_waitcnt lgkmcnt(13)
    ds_read_b64_tr_b16 v[124:125], v1 offset:43040
    ds_read_b64_tr_b16 v[126:127], v1 offset:43552
    s_waitcnt lgkmcnt(8)
    v_mfma_f32_32x32x16_bf16 v[80:95], v[120:123], v[136:139], v[80:95]
    ds_read_b128 v[128:131], v8 offset:64
    ds_read_b64_tr_b16 v[96:97], v10 offset:49184
    ds_read_b64_tr_b16 v[98:99], v10 offset:50208
    v_mfma_f32_32x32x16_bf16 v[16:31], v[104:107], v[136:139], v[16:31]
    ds_read_b64_tr_b16 v[100:101], v10 offset:49216
    ds_read_b64_tr_b16 v[102:103], v10 offset:50240
    s_add_u32 m0, s59, 34304
    s_add_u32 s98, s65, 14336
    buffer_load_dwordx4 v5, s[20:23], s98 offen lds
    v_mfma_f32_32x32x16_bf16 v[32:47], v[108:111], v[136:139], v[32:47]
    ds_read_b128 v[132:135], v0 offset:64
    v_mfma_f32_32x32x16_bf16 v[48:63], v[104:107], v[140:143], v[48:63]
    s_add_u32 m0, s59, 50720
    s_add_u32 s98, s65, 14336
    buffer_load_dwordx4 v5, s[24:27], s98 offen lds
    v_mfma_f32_32x32x16_bf16 v[64:79], v[108:111], v[140:143], v[64:79]
    s_waitcnt lgkmcnt(6)
    v_mfma_f32_32x32x16_bf16 v[80:95], v[124:127], v[144:147], v[80:95]
    ds_read_b128 v[136:139], v8 offset:96
    ds_read_b64_tr_b16 v[104:105], v10 offset:53280
    ds_read_b64_tr_b16 v[106:107], v10 offset:54304
    s_add_u32 m0, s62, 66080
    s_add_u32 s98, s66, 0
    buffer_load_dwordx4 v6, s[8:11], s98 offen lds
    v_mfma_f32_32x32x16_bf16 v[16:31], v[112:115], v[144:147], v[16:31]
    ds_read_b64_tr_b16 v[108:109], v10 offset:53312
    ds_read_b64_tr_b16 v[110:111], v10 offset:54336
    v_mfma_f32_32x32x16_bf16 v[32:47], v[116:119], v[144:147], v[32:47]
    ds_read_b128 v[140:143], v0 offset:96
    v_mfma_f32_32x32x16_bf16 v[48:63], v[112:115], v[148:151], v[48:63]
    v_mfma_f32_32x32x16_bf16 v[64:79], v[116:119], v[148:151], v[64:79]
    s_waitcnt vmcnt(5) lgkmcnt(0)
    s_barrier
    s_cmp_eq_u32 s44, 1
    s_cbranch_scc1 L_kvi
L_kvi_r:
    v_mfma_f32_32x32x16_bf16 v[16:31], v[96:99], v[128:131], v[16:31]
    ds_read_b128 v[144:147], v7 offset:16640
    ds_read_b64_tr_b16 v[112:113], v192 offset:0
    ds_read_b64_tr_b16 v[114:115], v192 offset:1024
    s_add_u32 s99, s63, 1
    s_mul_i32 s98, s99, 21846
    s_lshr_b32 s98, s98, 16
    s_mul_i32 s98, s98, 3
    s_sub_u32 s99, s99, s98
    s_add_u32 s99, s99, 5
    s_lshl_b32 s64, s99, 7
    s_add_u32 s64, s64, s52
    s_add_u32 m0, s53, 0
    s_add_u32 s98, s64, 0
    buffer_load_dwordx4 v4, s[4:7], s98 offen lds
    v_mfma_f32_32x32x16_bf16 v[32:47], v[100:103], v[128:131], v[32:47]
    ds_read_b64_tr_b16 v[116:117], v192 offset:32
    ds_read_b64_tr_b16 v[118:119], v192 offset:1056
    v_mfma_f32_32x32x16_bf16 v[48:63], v[96:99], v[132:135], v[48:63]
    ds_read_b128 v[148:151], v15 offset:16640
    s_add_u32 m0, s53, 1040
    s_add_u32 s98, s64, 1024
    buffer_load_dwordx4 v4, s[4:7], s98 offen lds
    v_mfma_f32_32x32x16_bf16 v[64:79], v[100:103], v[132:135], v[64:79]
    ds_read_b64_tr_b16 v[120:121], v194 offset:0
    ds_read_b64_tr_b16 v[122:123], v194 offset:512
    v_mfma_f32_32x32x16_bf16 v[16:31], v[104:107], v[136:139], v[16:31]
    ds_read_b128 v[128:131], v7 offset:16672
    ds_read_b64_tr_b16 v[96:97], v192 offset:4096
    ds_read_b64_tr_b16 v[98:99], v192 offset:5120
    s_add_u32 s99, s63, 2
    s_mul_i32 s98, s99, 21846
    s_lshr_b32 s98, s98, 16
    s_mul_i32 s98, s98, 3
    s_sub_u32 s99, s99, s98
    s_add_u32 s99, s99, 5
    s_mul_i32 s65, s99, 229376
    s_add_u32 s65, s65, s54
    s_lshl_b32 s66, s99, 16
    s_add_u32 s66, s66, s55
    s_add_u32 m0, s59, 74272
    s_add_u32 s98, s65, 0
    buffer_load_dwordx4 v5, s[20:23], s98 offen lds
    v_mfma_f32_32x32x16_bf16 v[32:47], v[108:111], v[136:139], v[32:47]
    ds_read_b64_tr_b16 v[100:101], v192 offset:4128
    ds_read_b64_tr_b16 v[102:103], v192 offset:5152
    v_mfma_f32_32x32x16_bf16 v[48:63], v[104:107], v[140:143], v[48:63]
    ds_read_b128 v[132:135], v15 offset:16672
    s_add_u32 m0, s59, 90688
    s_add_u32 s98, s65, 0
    buffer_load_dwordx4 v5, s[24:27], s98 offen lds
    v_mfma_f32_32x32x16_bf16 v[64:79], v[108:111], v[140:143], v[64:79]
    s_waitcnt lgkmcnt(13)
    ds_read_b64_tr_b16 v[124:125], v194 offset:2048
    ds_read_b64_tr_b16 v[126:127], v194 offset:2560
    s_waitcnt lgkmcnt(8)
    v_mfma_f32_32x32x16_bf16 v[80:95], v[120:123], v[144:147], v[80:95]
    ds_read_b128 v[136:139], v8 offset:16704
    ds_read_b64_tr_b16 v[104:105], v193 offset:8192
    ds_read_b64_tr_b16 v[106:107], v193 offset:9216
    v_mfma_f32_32x32x16_bf16 v[16:31], v[112:115], v[144:147], v[16:31]
    ds_read_b64_tr_b16 v[108:109], v193 offset:8224
    ds_read_b64_tr_b16 v[110:111], v193 offset:9248
    s_add_u32 m0, s59, 75296
    s_add_u32 s98, s65, 14336
    buffer_load_dwordx4 v5, s[20:23], s98 offen lds
    v_mfma_f32_32x32x16_bf16 v[32:47], v[116:119], v[144:147], v[32:47]
    ds_read_b128 v[140:143], v0 offset:16704
    v_mfma_f32_32x32x16_bf16 v[48:63], v[112:115], v[148:151], v[48:63]
    s_add_u32 m0, s59, 91712
    s_add_u32 s98, s65, 14336
    buffer_load_dwordx4 v5, s[24:27], s98 offen lds
    v_mfma_f32_32x32x16_bf16 v[64:79], v[116:119], v[148:151], v[64:79]
    s_waitcnt lgkmcnt(6)
    v_mfma_f32_32x32x16_bf16 v[80:95], v[124:127], v[128:131], v[80:95]
    ds_read_b128 v[144:147], v8 offset:16736
    ds_read_b64_tr_b16 v[112:113], v193 offset:12288
    ds_read_b64_tr_b16 v[114:115], v193 offset:13312
    s_add_u32 m0, s62, 107072
    s_add_u32 s98, s66, 0
    buffer_load_dwordx4 v6, s[8:11], s98 offen lds
    v_mfma_f32_32x32x16_bf16 v[16:31], v[96:99], v[128:131], v[16:31]
    ds_read_b64_tr_b16 v[116:117], v193 offset:12320
    ds_read_b64_tr_b16 v[118:119], v193 offset:13344
    v_mfma_f32_32x32x16_bf16 v[32:47], v[100:103], v[128:131], v[32:47]
    ds_read_b128 v[148:151], v0 offset:16736
    v_mfma_f32_32x32x16_bf16 v[48:63], v[96:99], v[132:135], v[48:63]
    v_mfma_f32_32x32x16_bf16 v[64:79], v[100:103], v[132:135], v[64:79]
    s_cmp_eq_u32 s44, 1
    s_cbranch_scc1 L_kvc
L_kvc_r:
    s_waitcnt vmcnt(5) lgkmcnt(0)
    s_barrier
    v_mfma_f32_32x32x16_bf16 v[16:31], v[104:107], v[136:139], v[16:31]
    ds_read_b128 v[128:131], v7 offset:0
    ds_read_b64_tr_b16 v[96:97], v9 offset:0
    ds_read_b64_tr_b16 v[98:99], v9 offset:1024
    s_add_u32 s99, s63, 2
    s_mul_i32 s98, s99, 21846
    s_lshr_b32 s98, s98, 16
    s_mul_i32 s98, s98, 3
    s_sub_u32 s99, s99, s98
    s_add_u32 s99, s99, 5
    s_lshl_b32 s64, s99, 7
    s_add_u32 s64, s64, s52
    s_add_u32 m0, s53, 16640
    s_add_u32 s98, s64, 0
    buffer_load_dwordx4 v4, s[4:7], s98 offen lds
    v_lshrrev_b32 v13, 5, v2
    v_lshlrev_b32 v13, 9, v13
    v_mfma_f32_32x32x16_bf16 v[32:47], v[108:111], v[136:139], v[32:47]
    ds_read_b64_tr_b16 v[100:101], v9 offset:32
    ds_read_b64_tr_b16 v[102:103], v9 offset:1056
    v_bfe_u32 v12, v2, 2, 2
    v_lshl_add_u32 v13, v12, 7, v13
    v_mfma_f32_32x32x16_bf16 v[48:63], v[104:107], v[140:143], v[48:63]
    ds_read_b128 v[132:135], v15 offset:0
    s_add_u32 m0, s53, 17680
    s_add_u32 s98, s64, 1024
    buffer_load_dwordx4 v4, s[4:7], s98 offen lds
    v_bfe_u32 v12, v2, 3, 1
    v_lshl_add_u32 v13, v12, 6, v13
    v_mfma_f32_32x32x16_bf16 v[64:79], v[108:111], v[140:143], v[64:79]
    ds_read_b64_tr_b16 v[120:121], v1 offset:0
    ds_read_b64_tr_b16 v[122:123], v1 offset:512
    v_bfe_u32 v12, v2, 4, 1
    v_lshl_add_u32 v13, v12, 5, v13
    v_mfma_f32_32x32x16_bf16 v[16:31], v[112:115], v[144:147], v[16:31]
    ds_read_b128 v[136:139], v7 offset:32
    ds_read_b64_tr_b16 v[104:105], v9 offset:4096
    ds_read_b64_tr_b16 v[106:107], v9 offset:5120
    v_and_b32 v12, 3, v2
    v_lshl_add_u32 v5, v12, 3, v13
    v_mfma_f32_32x32x16_bf16 v[32:47], v[116:119], v[144:147], v[32:47]
    ds_read_b64_tr_b16 v[108:109], v9 offset:4128
    ds_read_b64_tr_b16 v[110:111], v9 offset:5152
    s_add_u32 m0, s62, 131072
    s_add_u32 s98, s62, 0
    buffer_load_dwordx4 v3, s[40:43], s98 offen sc1 lds
    s_lshr_b32 s99, s44, 1
    s_lshl_b32 s100, s99, 13
    v_add_u32 v5, s100, v5
    v_mfma_f32_32x32x16_bf16 v[48:63], v[112:115], v[148:151], v[48:63]
    ds_read_b128 v[140:143], v15 offset:32
    v_mfma_f32_32x32x16_bf16 v[64:79], v[116:119], v[148:151], v[64:79]
    s_waitcnt lgkmcnt(13)
    ds_read_b64_tr_b16 v[124:125], v1 offset:2048
    ds_read_b64_tr_b16 v[126:127], v1 offset:2560
    s_waitcnt lgkmcnt(8)
    v_mfma_f32_32x32x16_bf16 v[80:95], v[120:123], v[128:131], v[80:95]
    ds_read_b128 v[144:147], v8 offset:64
    ds_read_b64_tr_b16 v[112:113], v10 offset:8192
    ds_read_b64_tr_b16 v[114:115], v10 offset:9216
    s_add_u32 m0, s62, 139264
    s_add_u32 s98, s62, 8192
    buffer_load_dwordx4 v3, s[40:43], s98 offen sc1 lds
    v_mfma_f32_32x32x16_bf16 v[16:31], v[96:99], v[128:131], v[16:31]
    ds_read_b64_tr_b16 v[116:117], v10 offset:8224
    ds_read_b64_tr_b16 v[118:119], v10 offset:9248
    v_mfma_f32_32x32x16_bf16 v[32:47], v[100:103], v[128:131], v[32:47]
    ds_read_b128 v[148:151], v0 offset:64
    s_add_u32 m0, s62, 147456
    s_add_u32 s98, s62, 16384
    buffer_load_dwordx4 v3, s[40:43], s98 offen sc1 lds
    v_mfma_f32_32x32x16_bf16 v[48:63], v[96:99], v[132:135], v[48:63]
    v_mfma_f32_32x32x16_bf16 v[64:79], v[100:103], v[132:135], v[64:79]
    s_waitcnt lgkmcnt(6)
    v_mfma_f32_32x32x16_bf16 v[80:95], v[124:127], v[136:139], v[80:95]
    ds_read_b128 v[128:131], v8 offset:96
    ds_read_b64_tr_b16 v[96:97], v10 offset:12288
    ds_read_b64_tr_b16 v[98:99], v10 offset:13312
    s_add_u32 m0, s62, 155648
    s_add_u32 s98, s62, 24576
    buffer_load_dwordx4 v3, s[40:43], s98 offen sc1 lds
    v_mfma_f32_32x32x16_bf16 v[16:31], v[104:107], v[136:139], v[16:31]
    ds_read_b64_tr_b16 v[100:101], v10 offset:12320
    ds_read_b64_tr_b16 v[102:103], v10 offset:13344
    v_mfma_f32_32x32x16_bf16 v[32:47], v[108:111], v[136:139], v[32:47]
    ds_read_b128 v[132:135], v0 offset:96
    v_mfma_f32_32x32x16_bf16 v[48:63], v[104:107], v[140:143], v[48:63]
    v_mfma_f32_32x32x16_bf16 v[64:79], v[108:111], v[140:143], v[64:79]
    s_waitcnt vmcnt(4) lgkmcnt(0)
    s_barrier
    s_cmp_eq_u32 s44, 1
    s_cbranch_scc1 L_kvn
L_kvn_r:
    v_mfma_f32_32x32x16_bf16 v[16:31], v[112:115], v[144:147], v[16:31]
    ds_read_b128 v[136:139], v7 offset:16640
    ds_read_b64_tr_b16 v[104:105], v9 offset:40992
    ds_read_b64_tr_b16 v[106:107], v9 offset:42016
    v_mov_b64 v[236:237], -1
    v_mov_b64 v[238:239], -1
    buffer_store_dwordx4 v[236:239], v3, s[40:43], s57 offen sc1
    v_mfma_f32_32x32x16_bf16 v[32:47], v[116:119], v[144:147], v[32:47]
    ds_read_b64_tr_b16 v[108:109], v9 offset:41024
    ds_read_b64_tr_b16 v[110:111], v9 offset:42048
    v_mfma_f32_32x32x16_bf16 v[48:63], v[112:115], v[148:151], v[48:63]
    ds_read_b128 v[140:143], v15 offset:16640
    v_mfma_f32_32x32x16_bf16 v[64:79], v[116:119], v[148:151], v[64:79]
    ds_read_b64_tr_b16 v[120:121], v1 offset:40992
    ds_read_b64_tr_b16 v[122:123], v1 offset:41504
    v_mfma_f32_32x32x16_bf16 v[16:31], v[96:99], v[128:131], v[16:31]
    ds_read_b128 v[144:147], v7 offset:16672
    ds_read_b64_tr_b16 v[112:113], v9 offset:45088
    ds_read_b64_tr_b16 v[114:115], v9 offset:46112
    v_mfma_f32_32x32x16_bf16 v[32:47], v[100:103], v[128:131], v[32:47]
    ds_read_b64_tr_b16 v[116:117], v9 offset:45120
    ds_read_b64_tr_b16 v[118:119], v9 offset:46144
    v_mfma_f32_32x32x16_bf16 v[48:63], v[96:99], v[132:135], v[48:63]
    ds_read_b128 v[148:151], v15 offset:16672
    v_mfma_f32_32x32x16_bf16 v[64:79], v[100:103], v[132:135], v[64:79]
    s_waitcnt lgkmcnt(13)
    ds_read_b64_tr_b16 v[124:125], v1 offset:43040
    ds_read_b64_tr_b16 v[126:127], v1 offset:43552
    s_waitcnt lgkmcnt(8)
    v_mfma_f32_32x32x16_bf16 v[80:95], v[120:123], v[136:139], v[80:95]
    ds_read_b128 v[128:131], v8 offset:16704
    ds_read_b64_tr_b16 v[96:97], v10 offset:49184
    ds_read_b64_tr_b16 v[98:99], v10 offset:50208
    v_mfma_f32_32x32x16_bf16 v[16:31], v[104:107], v[136:139], v[16:31]
    ds_read_b64_tr_b16 v[100:101], v10 offset:49216
    ds_read_b64_tr_b16 v[102:103], v10 offset:50240
    v_mfma_f32_32x32x16_bf16 v[32:47], v[108:111], v[136:139], v[32:47]
    ds_read_b128 v[132:135], v0 offset:16704
    s_waitcnt lgkmcnt(6)
    v_mfma_f32_32x32x16_bf16 v[80:95], v[124:127], v[144:147], v[80:95]
    ds_read_b128 v[216:219], v8 offset:16736
    ds_read_b64_tr_b16 v[152:153], v10 offset:53280
    ds_read_b64_tr_b16 v[154:155], v10 offset:54304
    v_mfma_f32_32x32x16_bf16 v[16:31], v[112:115], v[144:147], v[16:31]
    ds_read_b64_tr_b16 v[156:157], v10 offset:53312
    ds_read_b64_tr_b16 v[158:159], v10 offset:54336
    v_mfma_f32_32x32x16_bf16 v[32:47], v[116:119], v[144:147], v[32:47]
    ds_read_b128 v[220:223], v0 offset:16736
    s_waitcnt lgkmcnt(6)
    v_mfma_f32_32x32x16_bf16 v[16:31], v[96:99], v[128:131], v[16:31]
    v_mfma_f32_32x32x16_bf16 v[32:47], v[100:103], v[128:131], v[32:47]
    s_lshl_b32 s99, s44, 12
    s_add_u32 s99, s99, 40960
    v_add_u32 v11, s99, v3
    ds_write_b128 v11, v[80:83] offset:0
    ds_write_b128 v11, v[84:87] offset:1024
    ds_write_b128 v11, v[88:91] offset:2048
    ds_write_b128 v11, v[92:95] offset:3072
    s_waitcnt lgkmcnt(4)
    v_mfma_f32_32x32x16_bf16 v[16:31], v[152:155], v[216:219], v[16:31]
    v_mfma_f32_32x32x16_bf16 v[32:47], v[156:159], v[216:219], v[32:47]
    s_and_b32 s99, s44, 3
    s_lshl_b32 s99, s99, 12
    s_lshl_b32 s100, s45, 11
    s_add_u32 s99, s99, s100
    s_add_u32 s99, s99, 40960
    v_add_u32 v11, s99, v3
    v_add_u32 v0, s100, v3
    v_mov_b32 v15, 0xdddddddd
    v_add_u32 v1, 65536, v0
    v_add_u32 v127, 131072, v0
    s_bitcmp1_b32 s46, 0
    s_cselect_b32 s99, -147456, 0
    s_cselect_b32 s100, 0, 147456
    s_add_u32 s52, s56, s99
    s_add_u32 s52, s52, s100
    v_mfma_f32_32x32x16_bf16 v[48:63], v[104:107], v[140:143], v[48:63]
    v_mul_f32 v224, v16, v16
    v_mul_f32 v225, v17, v17
    v_mul_f32 v226, v18, v18
    v_mul_f32 v227, v19, v19
    v_mul_f32 v228, v20, v20
    v_mul_f32 v229, v21, v21
    v_mul_f32 v230, v22, v22
    v_mul_f32 v231, v23, v23
    v_fma_f32 v224, v224, s51, v232
    v_mfma_f32_32x32x16_bf16 v[48:63], v[112:115], v[148:151], v[48:63]
    v_fma_f32 v225, v225, s51, v232
    v_fma_f32 v226, v226, s51, v232
    v_fma_f32 v227, v227, s51, v232
    v_fma_f32 v228, v228, s51, v232
    v_fma_f32 v229, v229, s51, v232
    v_fma_f32 v230, v230, s51, v232
    v_fma_f32 v231, v231, s51, v232
    v_mul_f32 v224, v224, v16
    v_mul_f32 v225, v225, v17
    v_mfma_f32_32x32x16_bf16 v[48:63], v[96:99], v[132:135], v[48:63]
    v_mul_f32 v226, v226, v18
    v_mul_f32 v227, v227, v19
    v_mul_f32 v228, v228, v20
    v_mul_f32 v229, v229, v21
    v_mul_f32 v230, v230, v22
    v_mul_f32 v231, v231, v23
    v_exp_f32 v224, v224
    v_exp_f32 v225, v225
    v_exp_f32 v226, v226
    v_mfma_f32_32x32x16_bf16 v[48:63], v[152:155], v[220:223], v[48:63]
    v_exp_f32 v227, v227
    v_exp_f32 v228, v228
    v_exp_f32 v229, v229
    v_exp_f32 v230, v230
    v_exp_f32 v231, v231
    v_add_f32 v224, 1.0, v224
    v_add_f32 v225, 1.0, v225
    v_add_f32 v226, 1.0, v226
    v_add_f32 v227, 1.0, v227
    v_mfma_f32_32x32x16_bf16 v[64:79], v[108:111], v[140:143], v[64:79]
    v_add_f32 v228, 1.0, v228
    v_add_f32 v229, 1.0, v229
    v_add_f32 v230, 1.0, v230
    v_add_f32 v231, 1.0, v231
    v_rcp_f32 v224, v224
    v_rcp_f32 v225, v225
    v_rcp_f32 v226, v226
    v_rcp_f32 v227, v227
    v_rcp_f32 v228, v228
    v_mfma_f32_32x32x16_bf16 v[64:79], v[116:119], v[148:151], v[64:79]
    v_rcp_f32 v229, v229
    v_rcp_f32 v230, v230
    v_rcp_f32 v231, v231
    v_mul_f32 v224, v224, v16
    v_mul_f32 v225, v225, v17
    v_mul_f32 v226, v226, v18
    v_mul_f32 v227, v227, v19
    v_mul_f32 v228, v228, v20
    v_mul_f32 v229, v229, v21
    v_mfma_f32_32x32x16_bf16 v[64:79], v[100:103], v[132:135], v[64:79]
    v_mul_f32 v230, v230, v22
    v_mul_f32 v231, v231, v23
    v_mul_f32 v224, v224, v24
    v_mul_f32 v225, v225, v25
    v_mul_f32 v226, v226, v26
    v_mul_f32 v227, v227, v27
    v_mul_f32 v228, v228, v28
    v_mul_f32 v229, v229, v29
    v_mul_f32 v230, v230, v30
    v_mfma_f32_32x32x16_bf16 v[64:79], v[156:159], v[220:223], v[64:79]
    v_mul_f32 v231, v231, v31
    v_cvt_pk_bf16_f32 v236, v224, v225
    v_cvt_pk_bf16_f32 v237, v226, v227
    v_cvt_pk_bf16_f32 v238, v228, v229
    v_cvt_pk_bf16_f32 v239, v230, v231
    s_add_u32 s99, s56, 0
    buffer_store_dwordx4 v[236:239], v3, s[40:43], s99 offen sc1
    v_pk_mul_f32 v[224:225], v[32:33], v[32:33]
    v_pk_mul_f32 v[226:227], v[34:35], v[34:35]
    v_pk_mul_f32 v[228:229], v[36:37], v[36:37]
    v_pk_mul_f32 v[230:231], v[38:39], v[38:39]
    v_pk_fma_f32 v[224:225], v[224:225], v[234:235], v[232:233]
    v_pk_fma_f32 v[226:227], v[226:227], v[234:235], v[232:233]
    v_pk_fma_f32 v[228:229], v[228:229], v[234:235], v[232:233]
    v_pk_fma_f32 v[230:231], v[230:231], v[234:235], v[232:233]
    v_pk_mul_f32 v[224:225], v[224:225], v[32:33]
    v_pk_mul_f32 v[226:227], v[226:227], v[34:35]
    v_pk_mul_f32 v[228:229], v[228:229], v[36:37]
    v_pk_mul_f32 v[230:231], v[230:231], v[38:39]
    v_exp_f32 v224, v224
    v_exp_f32 v225, v225
    v_exp_f32 v226, v226
    v_exp_f32 v227, v227
    v_exp_f32 v228, v228
    v_exp_f32 v229, v229
    v_exp_f32 v230, v230
    v_exp_f32 v231, v231
    v_pk_add_f32 v[224:225], v[224:225], 1.0 op_sel_hi:[1,0]
    v_pk_add_f32 v[226:227], v[226:227], 1.0 op_sel_hi:[1,0]
    v_pk_add_f32 v[228:229], v[228:229], 1.0 op_sel_hi:[1,0]
    v_pk_add_f32 v[230:231], v[230:231], 1.0 op_sel_hi:[1,0]
    v_rcp_f32 v224, v224
    v_rcp_f32 v225, v225
    v_rcp_f32 v226, v226
    v_rcp_f32 v227, v227
    v_rcp_f32 v228, v228
    v_rcp_f32 v229, v229
    v_rcp_f32 v230, v230
    v_rcp_f32 v231, v231
    v_pk_mul_f32 v[224:225], v[224:225], v[32:33]
    v_pk_mul_f32 v[226:227], v[226:227], v[34:35]
    v_pk_mul_f32 v[228:229], v[228:229], v[36:37]
    v_pk_mul_f32 v[230:231], v[230:231], v[38:39]
    v_pk_mul_f32 v[224:225], v[224:225], v[40:41]
    v_pk_mul_f32 v[226:227], v[226:227], v[42:43]
    v_pk_mul_f32 v[228:229], v[228:229], v[44:45]
    v_pk_mul_f32 v[230:231], v[230:231], v[46:47]
    v_cvt_pk_bf16_f32 v236, v224, v225
    v_cvt_pk_bf16_f32 v237, v226, v227
    v_cvt_pk_bf16_f32 v238, v228, v229
    v_cvt_pk_bf16_f32 v239, v230, v231
    s_add_u32 s99, s56, 1024
    buffer_store_dwordx4 v[236:239], v3, s[40:43], s99 offen sc1
    s_waitcnt lgkmcnt(0)
    s_barrier
    ds_read_b128 v[240:243], v11
    ds_read_b128 v[244:247], v11 offset:1024
    ds_read_b128 v[248:251], v11 offset:16384
    ds_read_b128 v[252:255], v11 offset:17408
    v_pk_mul_f32 v[224:225], v[48:49], v[48:49]
    v_pk_mul_f32 v[226:227], v[50:51], v[50:51]
    v_pk_mul_f32 v[228:229], v[52:53], v[52:53]
    v_pk_mul_f32 v[230:231], v[54:55], v[54:55]
    v_pk_fma_f32 v[224:225], v[224:225], v[234:235], v[232:233]
    v_pk_fma_f32 v[226:227], v[226:227], v[234:235], v[232:233]
    s_add_u32 m0, s62, 0
    s_add_u32 s98, s62, 32768
    buffer_load_dwordx4 v3, s[40:43], s98 offen sc1 lds
    v_pk_fma_f32 v[228:229], v[228:229], v[234:235], v[232:233]
    v_pk_fma_f32 v[230:231], v[230:231], v[234:235], v[232:233]
    v_pk_mul_f32 v[224:225], v[224:225], v[48:49]
    v_pk_mul_f32 v[226:227], v[226:227], v[50:51]
    v_pk_mul_f32 v[228:229], v[228:229], v[52:53]
    v_pk_mul_f32 v[230:231], v[230:231], v[54:55]
    s_add_u32 m0, s62, 8192
    s_add_u32 s98, s62, 40960
    buffer_load_dwordx4 v3, s[40:43], s98 offen sc1 lds
    v_exp_f32 v224, v224
    v_exp_f32 v225, v225
    v_exp_f32 v226, v226
    v_exp_f32 v227, v227
    v_exp_f32 v228, v228
    v_exp_f32 v229, v229
    v_exp_f32 v230, v230
    v_exp_f32 v231, v231
    s_add_u32 m0, s62, 16384
    s_add_u32 s98, s62, 49152
    buffer_load_dwordx4 v3, s[40:43], s98 offen sc1 lds
    v_pk_add_f32 v[224:225], v[224:225], 1.0 op_sel_hi:[1,0]
    v_pk_add_f32 v[226:227], v[226:227], 1.0 op_sel_hi:[1,0]
    v_pk_add_f32 v[228:229], v[228:229], 1.0 op_sel_hi:[1,0]
    v_pk_add_f32 v[230:231], v[230:231], 1.0 op_sel_hi:[1,0]
    v_rcp_f32 v224, v224
    v_rcp_f32 v225, v225
    v_rcp_f32 v226, v226
    v_rcp_f32 v227, v227
    s_add_u32 m0, s62, 24576
    s_add_u32 s98, s62, 57344
    buffer_load_dwordx4 v3, s[40:43], s98 offen sc1 lds
    v_rcp_f32 v228, v228
    v_rcp_f32 v229, v229
    v_rcp_f32 v230, v230
    v_rcp_f32 v231, v231
    v_pk_mul_f32 v[224:225], v[224:225], v[48:49]
    v_pk_mul_f32 v[226:227], v[226:227], v[50:51]
    v_pk_mul_f32 v[228:229], v[228:229], v[52:53]
    v_pk_mul_f32 v[230:231], v[230:231], v[54:55]
    v_pk_mul_f32 v[224:225], v[224:225], v[56:57]
    v_pk_mul_f32 v[226:227], v[226:227], v[58:59]
    v_pk_mul_f32 v[228:229], v[228:229], v[60:61]
    v_pk_mul_f32 v[230:231], v[230:231], v[62:63]
    v_cvt_pk_bf16_f32 v236, v224, v225
    v_cvt_pk_bf16_f32 v237, v226, v227
    v_cvt_pk_bf16_f32 v238, v228, v229
    v_cvt_pk_bf16_f32 v239, v230, v231
    s_add_u32 s99, s52, 0
    buffer_store_dwordx4 v[236:239], v3, s[40:43], s99 offen sc1
    s_waitcnt lgkmcnt(0)
    s_mov_b32 s101, 1052289595
    v_pk_add_f32 v[240:241], v[240:241], v[248:249]
    v_pk_add_f32 v[242:243], v[242:243], v[250:251]
    v_pk_add_f32 v[244:245], v[244:245], v[252:253]
    v_pk_add_f32 v[246:247], v[246:247], v[254:255]
    v_mul_f32 v240, s101, v240
    v_mul_f32 v241, s101, v241
    v_mul_f32 v242, s101, v242
    v_mul_f32 v243, s101, v243
    v_mul_f32 v244, s101, v244
    v_mul_f32 v245, s101, v245
    v_mul_f32 v246, s101, v246
    v_mul_f32 v247, s101, v247
    v_cvt_pk_bf16_f32 v120, v240, v241
    v_cvt_pk_bf16_f32 v121, v242, v243
    v_cvt_pk_bf16_f32 v122, v244, v245
    v_cvt_pk_bf16_f32 v123, v246, v247
    v_mul_f32 v124, v240, v240
    v_fmac_f32 v124, v241, v241
    v_fmac_f32 v124, v242, v242
    v_fmac_f32 v124, v243, v243
    v_fmac_f32 v124, v244, v244
    v_fmac_f32 v124, v245, v245
    v_fmac_f32 v124, v246, v246
    v_fmac_f32 v124, v247, v247
    v_mov_b32 v12, v124
    s_lshl_b32 s99, s44, 11
    s_add_u32 s99, s99, 98304
    v_add_u32 v13, s99, v3
    v_permlane32_swap_b32 v124, v12
    v_mov_b32 v11, 120000
    v_add_f32 v124, v124, v12
    ds_write_b128 v13, v[120:123]
    ds_write_b32 v13, v124 offset:1024
    v_xor_b32 v13, 8192, v13
    s_setprio 3
    s_waitcnt vmcnt(8) lgkmcnt(0)
    s_barrier
    ds_read_b32 v125, v11
    ds_read_b128 v[192:195], v127 offset:0
    ds_read_b32 v4, v13 offset:1024
    ds_read_b128 v[196:199], v13
    s_mov_b64 exec, s[60:61]
    ds_read_b128 v[176:179], v127 offset:1024
    ds_read_b128 v[180:183], v127 offset:1280
    s_mov_b64 exec, -1
    v_pk_mul_f32 v[224:225], v[64:65], v[64:65]
    v_pk_mul_f32 v[226:227], v[66:67], v[66:67]
    v_pk_mul_f32 v[228:229], v[68:69], v[68:69]
    v_pk_mul_f32 v[230:231], v[70:71], v[70:71]
    v_pk_fma_f32 v[224:225], v[224:225], v[234:235], v[232:233]
    v_pk_fma_f32 v[226:227], v[226:227], v[234:235], v[232:233]
    v_pk_fma_f32 v[228:229], v[228:229], v[234:235], v[232:233]
    v_pk_fma_f32 v[230:231], v[230:231], v[234:235], v[232:233]
    v_pk_mul_f32 v[224:225], v[224:225], v[64:65]
    v_pk_mul_f32 v[226:227], v[226:227], v[66:67]
    v_pk_mul_f32 v[228:229], v[228:229], v[68:69]
    v_pk_mul_f32 v[230:231], v[230:231], v[70:71]
    v_exp_f32 v224, v224
    v_exp_f32 v225, v225
    v_exp_f32 v226, v226
    v_exp_f32 v227, v227
    v_exp_f32 v228, v228
    v_exp_f32 v229, v229
    v_exp_f32 v230, v230
    v_exp_f32 v231, v231
    v_pk_add_f32 v[224:225], v[224:225], 1.0 op_sel_hi:[1,0]
    v_pk_add_f32 v[226:227], v[226:227], 1.0 op_sel_hi:[1,0]
    v_pk_add_f32 v[228:229], v[228:229], 1.0 op_sel_hi:[1,0]
    v_pk_add_f32 v[230:231], v[230:231], 1.0 op_sel_hi:[1,0]
    s_waitcnt lgkmcnt(0)
    v_mfma_f32_32x32x16_bf16 v[16:31], v[192:195], v[120:123], 0
    v_max_f32 v124, v124, v4
    v_mul_f32 v124, v124, v125
    s_mov_b32 s100, 1158676480
    v_cmp_nge_f32 vcc, s100, v124
    v_rcp_f32 v224, v224
    v_rcp_f32 v225, v225
    v_rcp_f32 v226, v226
    v_rcp_f32 v227, v227
    v_rcp_f32 v228, v228
    v_rcp_f32 v229, v229
    v_rcp_f32 v230, v230
    v_rcp_f32 v231, v231
    v_pk_mul_f32 v[224:225], v[224:225], v[64:65]
    v_pk_mul_f32 v[226:227], v[226:227], v[66:67]
    v_pk_mul_f32 v[228:229], v[228:229], v[68:69]
    v_pk_mul_f32 v[230:231], v[230:231], v[70:71]
    v_pk_mul_f32 v[224:225], v[224:225], v[72:73]
    v_pk_mul_f32 v[226:227], v[226:227], v[74:75]
    v_pk_mul_f32 v[228:229], v[228:229], v[76:77]
    v_pk_mul_f32 v[230:231], v[230:231], v[78:79]
    v_cvt_pk_bf16_f32 v236, v224, v225
    v_cvt_pk_bf16_f32 v237, v226, v227
    v_cvt_pk_bf16_f32 v238, v228, v229
    v_cvt_pk_bf16_f32 v239, v230, v231
    s_add_u32 s99, s52, 1024
    buffer_store_dwordx4 v[236:239], v3, s[40:43], s99 offen sc1
L_join:
    s_cbranch_vccnz L_slow
    s_setprio 3
    v_exp_f32 v16, v16
    v_exp_f32 v17, v17
    v_exp_f32 v18, v18
    s_mov_b64 exec, s[60:61]
    ds_read_b128 v[184:187], v127 offset:5120
    ds_read_b128 v[188:191], v127 offset:5376
    s_mov_b64 exec, -1
    v_exp_f32 v19, v19
    v_exp_f32 v20, v20
    v_exp_f32 v21, v21
    v_mfma_f32_32x32x16_bf16 v[32:47], v[192:195], v[196:199], 0
    ds_read_b128 v[192:195], v127 offset:4096
    v_exp_f32 v22, v22
    v_exp_f32 v23, v23
    v_exp_f32 v24, v24
    v_exp_f32 v25, v25
    v_smfmac_f32_32x32x32_bf16 v[160:175], v[176:179], v[16:23], v15
    s_add_u32 m0, s62, 32768
    s_add_u32 s98, s62, 65536
    buffer_load_dwordx4 v3, s[40:43], s98 offen sc1 lds
    v_exp_f32 v26, v26
    v_exp_f32 v27, v27
    v_exp_f32 v28, v28
    v_exp_f32 v29, v29
    v_exp_f32 v30, v30
    v_exp_f32 v31, v31
    s_setprio 2
    v_exp_f32 v32, v32
    v_exp_f32 v33, v33
    v_exp_f32 v34, v34
    v_smfmac_f32_32x32x32_bf16 v[160:175], v[180:183], v[24:31], v15
    v_exp_f32 v35, v35
    v_exp_f32 v36, v36
    v_exp_f32 v37, v37
    s_waitcnt lgkmcnt(0)
    v_mfma_f32_32x32x16_bf16 v[16:31], v[192:195], v[120:123], 0
    v_exp_f32 v38, v38
    v_exp_f32 v39, v39
    v_exp_f32 v40, v40
    v_exp_f32 v41, v41
    v_smfmac_f32_32x32x32_bf16 v[200:215], v[176:179], v[32:39], v15
    s_add_u32 m0, s62, 40960
    s_add_u32 s98, s62, 73728
    buffer_load_dwordx4 v3, s[40:43], s98 offen sc1 lds
    v_exp_f32 v42, v42
    v_exp_f32 v43, v43
    v_exp_f32 v44, v44
    v_exp_f32 v45, v45
    v_exp_f32 v46, v46
    v_exp_f32 v47, v47
    s_setprio 1
    v_exp_f32 v16, v16
    v_exp_f32 v17, v17
    v_exp_f32 v18, v18
    v_smfmac_f32_32x32x32_bf16 v[200:215], v[180:183], v[40:47], v15
    s_mov_b64 exec, s[60:61]
    ds_read_b128 v[176:179], v127 offset:9216
    ds_read_b128 v[180:183], v127 offset:9472
    s_mov_b64 exec, -1
    v_exp_f32 v19, v19
    v_exp_f32 v20, v20
    v_exp_f32 v21, v21
    v_mfma_f32_32x32x16_bf16 v[32:47], v[192:195], v[196:199], 0
    ds_read_b128 v[192:195], v127 offset:8192
    v_exp_f32 v22, v22
    v_exp_f32 v23, v23
    v_exp_f32 v24, v24
    v_exp_f32 v25, v25
    v_smfmac_f32_32x32x32_bf16 v[160:175], v[184:187], v[16:23], v15
    s_add_u32 m0, s62, 49152
    s_add_u32 s98, s62, 81920
    buffer_load_dwordx4 v3, s[40:43], s98 offen sc1 lds
    v_exp_f32 v26, v26
    v_exp_f32 v27, v27
    v_exp_f32 v28, v28
    v_exp_f32 v29, v29
    v_exp_f32 v30, v30
    v_exp_f32 v31, v31
    s_setprio 0
    v_exp_f32 v32, v32
    v_exp_f32 v33, v33
    v_exp_f32 v34, v34
    v_smfmac_f32_32x32x32_bf16 v[160:175], v[188:191], v[24:31], v15
    v_exp_f32 v35, v35
    v_exp_f32 v36, v36
    v_exp_f32 v37, v37
    s_waitcnt lgkmcnt(0)
    v_mfma_f32_32x32x16_bf16 v[16:31], v[192:195], v[120:123], 0
    v_exp_f32 v38, v38
    v_exp_f32 v39, v39
    v_exp_f32 v40, v40
    v_exp_f32 v41, v41
    v_smfmac_f32_32x32x32_bf16 v[200:215], v[184:187], v[32:39], v15
    s_add_u32 m0, s62, 57344
    s_add_u32 s98, s62, 90112
    buffer_load_dwordx4 v3, s[40:43], s98 offen sc1 lds
    v_exp_f32 v42, v42
    v_exp_f32 v43, v43
    v_exp_f32 v44, v44
    v_exp_f32 v45, v45
    v_exp_f32 v46, v46
    v_exp_f32 v47, v47
    s_setprio 3
    v_exp_f32 v16, v16
    v_exp_f32 v17, v17
    v_exp_f32 v18, v18
    v_smfmac_f32_32x32x32_bf16 v[200:215], v[188:191], v[40:47], v15
    s_mov_b64 exec, s[60:61]
    ds_read_b128 v[184:187], v127 offset:13312
    ds_read_b128 v[188:191], v127 offset:13568
    s_mov_b64 exec, -1
    v_exp_f32 v19, v19
    v_exp_f32 v20, v20
    v_exp_f32 v21, v21
    v_mfma_f32_32x32x16_bf16 v[32:47], v[192:195], v[196:199], 0
    ds_read_b128 v[192:195], v127 offset:12288
    v_exp_f32 v22, v22
    v_exp_f32 v23, v23
    v_exp_f32 v24, v24
    v_exp_f32 v25, v25
    v_smfmac_f32_32x32x32_bf16 v[160:175], v[176:179], v[16:23], v15
    s_add_u32 m0, s62, 65536
    s_add_u32 s98, s62, 98304
    buffer_load_dwordx4 v3, s[40:43], s98 offen sc1 lds
    v_exp_f32 v26, v26
    v_exp_f32 v27, v27
    v_exp_f32 v28, v28
    v_exp_f32 v29, v29
    v_exp_f32 v30, v30
    v_exp_f32 v31, v31
    v_mov_b32 v12, s49
    v_mov_b32 v11, 0
    s_waitcnt vmcnt(5)
    s_mov_b64 exec, 1
    buffer_store_dword v12, v11, s[40:43], s58 offen sc1
    s_mov_b64 exec, -1
    s_setprio 2
    v_exp_f32 v32, v32
    v_exp_f32 v33, v33
    v_exp_f32 v34, v34
    v_smfmac_f32_32x32x32_bf16 v[160:175], v[180:183], v[24:31], v15
    v_exp_f32 v35, v35
    v_exp_f32 v36, v36
    v_exp_f32 v37, v37
    s_waitcnt lgkmcnt(0)
    v_mfma_f32_32x32x16_bf16 v[16:31], v[192:195], v[120:123], 0
    v_exp_f32 v38, v38
    v_exp_f32 v39, v39
    v_exp_f32 v40, v40
    v_exp_f32 v41, v41
    v_smfmac_f32_32x32x32_bf16 v[200:215], v[176:179], v[32:39], v15
    s_add_u32 m0, s62, 73728
    s_add_u32 s98, s62, 106496
    buffer_load_dwordx4 v3, s[40:43], s98 offen sc1 lds
    v_exp_f32 v42, v42
    v_exp_f32 v43, v43
    v_exp_f32 v44, v44
    v_exp_f32 v45, v45
    v_exp_f32 v46, v46
    v_exp_f32 v47, v47
    s_setprio 1
    v_exp_f32 v16, v16
    v_exp_f32 v17, v17
    v_exp_f32 v18, v18
    v_smfmac_f32_32x32x32_bf16 v[200:215], v[180:183], v[40:47], v15
    s_mov_b64 exec, s[60:61]
    ds_read_b128 v[176:179], v127 offset:17408
    ds_read_b128 v[180:183], v127 offset:17664
    s_mov_b64 exec, -1
    v_exp_f32 v19, v19
    v_exp_f32 v20, v20
    v_exp_f32 v21, v21
    v_mfma_f32_32x32x16_bf16 v[32:47], v[192:195], v[196:199], 0
    ds_read_b128 v[192:195], v127 offset:16384
    v_exp_f32 v22, v22
    v_exp_f32 v23, v23
    v_exp_f32 v24, v24
    v_exp_f32 v25, v25
    v_smfmac_f32_32x32x32_bf16 v[160:175], v[184:187], v[16:23], v15
    s_add_u32 m0, s62, 81920
    s_add_u32 s98, s62, 114688
    buffer_load_dwordx4 v3, s[40:43], s98 offen sc1 lds
    v_exp_f32 v26, v26
    v_exp_f32 v27, v27
    v_exp_f32 v28, v28
    v_exp_f32 v29, v29
    v_exp_f32 v30, v30
    v_exp_f32 v31, v31
    s_setprio 0
    v_exp_f32 v32, v32
    v_exp_f32 v33, v33
    v_exp_f32 v34, v34
    v_smfmac_f32_32x32x32_bf16 v[160:175], v[188:191], v[24:31], v15
    v_exp_f32 v35, v35
    v_exp_f32 v36, v36
    v_exp_f32 v37, v37
    s_waitcnt lgkmcnt(0)
    v_mfma_f32_32x32x16_bf16 v[16:31], v[192:195], v[120:123], 0
    v_exp_f32 v38, v38
    v_exp_f32 v39, v39
    v_exp_f32 v40, v40
    v_exp_f32 v41, v41
    v_smfmac_f32_32x32x32_bf16 v[200:215], v[184:187], v[32:39], v15
    s_add_u32 m0, s62, 90112
    s_add_u32 s98, s62, 122880
    buffer_load_dwordx4 v3, s[40:43], s98 offen sc1 lds
    v_exp_f32 v42, v42
    v_exp_f32 v43, v43
    v_exp_f32 v44, v44
    v_exp_f32 v45, v45
    v_exp_f32 v46, v46
    v_exp_f32 v47, v47
    s_setprio 3
    v_exp_f32 v16, v16
    v_exp_f32 v17, v17
    v_exp_f32 v18, v18
    v_smfmac_f32_32x32x32_bf16 v[200:215], v[188:191], v[40:47], v15
    s_mov_b64 exec, s[60:61]
    ds_read_b128 v[184:187], v127 offset:21504
    ds_read_b128 v[188:191], v127 offset:21760
    s_mov_b64 exec, -1
    v_exp_f32 v19, v19
    v_exp_f32 v20, v20
    v_exp_f32 v21, v21
    v_mfma_f32_32x32x16_bf16 v[32:47], v[192:195], v[196:199], 0
    ds_read_b128 v[192:195], v127 offset:20480
    v_exp_f32 v22, v22
    v_exp_f32 v23, v23
    v_exp_f32 v24, v24
    v_exp_f32 v25, v25
    v_smfmac_f32_32x32x32_bf16 v[160:175], v[176:179], v[16:23], v15
    v_exp_f32 v26, v26
    v_exp_f32 v27, v27
    v_exp_f32 v28, v28
    v_exp_f32 v29, v29
    v_exp_f32 v30, v30
    v_exp_f32 v31, v31
    s_setprio 2
    v_exp_f32 v32, v32
    v_exp_f32 v33, v33
    v_exp_f32 v34, v34
    v_smfmac_f32_32x32x32_bf16 v[160:175], v[180:183], v[24:31], v15
    v_exp_f32 v35, v35
    v_exp_f32 v36, v36
    v_exp_f32 v37, v37
    s_waitcnt lgkmcnt(0)
    v_mfma_f32_32x32x16_bf16 v[16:31], v[192:195], v[120:123], 0
    v_exp_f32 v38, v38
    v_exp_f32 v39, v39
    v_exp_f32 v40, v40
    v_exp_f32 v41, v41
    v_smfmac_f32_32x32x32_bf16 v[200:215], v[176:179], v[32:39], v15
    v_exp_f32 v42, v42
    v_exp_f32 v43, v43
    v_exp_f32 v44, v44
    v_exp_f32 v45, v45
    v_exp_f32 v46, v46
    v_exp_f32 v47, v47
    s_setprio 1
    v_exp_f32 v16, v16
    v_exp_f32 v17, v17
    v_exp_f32 v18, v18
    v_smfmac_f32_32x32x32_bf16 v[200:215], v[180:183], v[40:47], v15
    s_mov_b64 exec, s[60:61]
    ds_read_b128 v[176:179], v127 offset:25600
    ds_read_b128 v[180:183], v127 offset:25856
    s_mov_b64 exec, -1
    v_exp_f32 v19, v19
    v_exp_f32 v20, v20
    v_exp_f32 v21, v21
    v_mfma_f32_32x32x16_bf16 v[32:47], v[192:195], v[196:199], 0
    ds_read_b128 v[192:195], v127 offset:24576
    v_exp_f32 v22, v22
    v_exp_f32 v23, v23
    v_exp_f32 v24, v24
    v_exp_f32 v25, v25
    v_smfmac_f32_32x32x32_bf16 v[160:175], v[184:187], v[16:23], v15
    v_lshlrev_b32 v11, 10, v2
    s_and_b32 s99, s47, 3
    s_lshl_b32 s99, s99, 1
    s_and_b32 s100, s48, 1
    s_add_u32 s99, s99, s100
    s_lshr_b32 s100, s48, 1
    s_lshl_b32 s100, s100, 7
    s_mul_i32 s101, s99, 229376
    s_add_u32 s101, s101, s100
    s_mul_i32 s98, s44, 28672
    s_add_u32 s101, s101, s98
    s_bfm_b64 exec, 28, 0
    buffer_load_dword v129, v11, s[28:31], s101 offen
    s_mov_b64 exec, -1
    v_exp_f32 v26, v26
    v_exp_f32 v27, v27
    v_exp_f32 v28, v28
    v_exp_f32 v29, v29
    v_exp_f32 v30, v30
    v_exp_f32 v31, v31
    s_setprio 0
    v_exp_f32 v32, v32
    v_exp_f32 v33, v33
    v_exp_f32 v34, v34
    v_smfmac_f32_32x32x32_bf16 v[160:175], v[188:191], v[24:31], v15
    v_exp_f32 v35, v35
    v_exp_f32 v36, v36
    v_exp_f32 v37, v37
    s_waitcnt lgkmcnt(0)
    v_mfma_f32_32x32x16_bf16 v[16:31], v[192:195], v[120:123], 0
    v_exp_f32 v38, v38
    v_exp_f32 v39, v39
    v_exp_f32 v40, v40
    v_exp_f32 v41, v41
    v_smfmac_f32_32x32x32_bf16 v[200:215], v[184:187], v[32:39], v15
    s_mul_i32 s101, s99, 65536
    s_add_u32 s101, s101, s100
    s_mul_i32 s98, s44, 8192
    s_add_u32 s101, s101, s98
    s_bfm_b64 exec, 8, 0
    buffer_load_dword v128, v11, s[16:19], s101 offen
    s_mov_b64 exec, -1
    v_exp_f32 v42, v42
    v_exp_f32 v43, v43
    v_exp_f32 v44, v44
    v_exp_f32 v45, v45
    v_exp_f32 v46, v46
    v_exp_f32 v47, v47
    s_setprio 3
    v_exp_f32 v16, v16
    v_exp_f32 v17, v17
    v_exp_f32 v18, v18
    v_smfmac_f32_32x32x32_bf16 v[200:215], v[188:191], v[40:47], v15
    s_mov_b64 exec, s[60:61]
    ds_read_b128 v[184:187], v127 offset:29696
    ds_read_b128 v[188:191], v127 offset:29952
    s_mov_b64 exec, -1
    v_exp_f32 v19, v19
    v_exp_f32 v20, v20
    v_exp_f32 v21, v21
    v_mfma_f32_32x32x16_bf16 v[32:47], v[192:195], v[196:199], 0
    ds_read_b128 v[192:195], v127 offset:28672
    v_exp_f32 v22, v22
    v_exp_f32 v23, v23
    v_exp_f32 v24, v24
    v_exp_f32 v25, v25
    v_smfmac_f32_32x32x32_bf16 v[160:175], v[176:179], v[16:23], v15
    v_exp_f32 v26, v26
    v_exp_f32 v27, v27
    v_exp_f32 v28, v28
    v_exp_f32 v29, v29
    v_exp_f32 v30, v30
    v_exp_f32 v31, v31
    s_setprio 2
    v_exp_f32 v32, v32
    v_exp_f32 v33, v33
    v_exp_f32 v34, v34
    v_smfmac_f32_32x32x32_bf16 v[160:175], v[180:183], v[24:31], v15
    v_exp_f32 v35, v35
    v_exp_f32 v36, v36
    v_exp_f32 v37, v37
    s_waitcnt lgkmcnt(0)
    v_mfma_f32_32x32x16_bf16 v[16:31], v[192:195], v[120:123], 0
    v_exp_f32 v38, v38
    v_exp_f32 v39, v39
    v_exp_f32 v40, v40
    v_exp_f32 v41, v41
    v_smfmac_f32_32x32x32_bf16 v[200:215], v[176:179], v[32:39], v15
    v_exp_f32 v42, v42
    v_exp_f32 v43, v43
    v_exp_f32 v44, v44
    v_exp_f32 v45, v45
    v_exp_f32 v46, v46
    v_exp_f32 v47, v47
    s_waitcnt vmcnt(2)
    s_barrier
    s_setprio 1
    v_exp_f32 v16, v16
    v_exp_f32 v17, v17
    v_exp_f32 v18, v18
    v_smfmac_f32_32x32x32_bf16 v[200:215], v[180:183], v[40:47], v15
    s_mov_b64 exec, s[60:61]
    ds_read_b128 v[176:179], v0 offset:1024
    ds_read_b128 v[180:183], v0 offset:1280
    s_mov_b64 exec, -1
    v_exp_f32 v19, v19
    v_exp_f32 v20, v20
    v_exp_f32 v21, v21
    v_mfma_f32_32x32x16_bf16 v[32:47], v[192:195], v[196:199], 0
    ds_read_b128 v[192:195], v0 offset:0
    v_exp_f32 v22, v22
    v_exp_f32 v23, v23
    v_exp_f32 v24, v24
    v_exp_f32 v25, v25
    v_smfmac_f32_32x32x32_bf16 v[160:175], v[184:187], v[16:23], v15
    s_add_u32 m0, s62, 98304
    s_add_u32 s98, s55, 0
    buffer_load_dwordx4 v6, s[28:31], s98 offen lds
    v_exp_f32 v26, v26
    v_exp_f32 v27, v27
    v_exp_f32 v28, v28
    v_exp_f32 v29, v29
    v_exp_f32 v30, v30
    v_exp_f32 v31, v31
    s_setprio 0
    v_exp_f32 v32, v32
    v_exp_f32 v33, v33
    v_exp_f32 v34, v34
    v_smfmac_f32_32x32x32_bf16 v[160:175], v[188:191], v[24:31], v15
    v_exp_f32 v35, v35
    v_exp_f32 v36, v36
    v_exp_f32 v37, v37
    s_waitcnt lgkmcnt(0)
    v_mfma_f32_32x32x16_bf16 v[16:31], v[192:195], v[120:123], 0
    v_exp_f32 v38, v38
    v_exp_f32 v39, v39
    v_exp_f32 v40, v40
    v_exp_f32 v41, v41
    v_smfmac_f32_32x32x32_bf16 v[200:215], v[184:187], v[32:39], v15
    s_add_u32 m0, s62, 106496
    s_add_u32 s98, s55, 65536
    buffer_load_dwordx4 v6, s[28:31], s98 offen lds
    v_exp_f32 v42, v42
    v_exp_f32 v43, v43
    v_exp_f32 v44, v44
    v_exp_f32 v45, v45
    v_exp_f32 v46, v46
    v_exp_f32 v47, v47
    s_setprio 3
    v_exp_f32 v16, v16
    v_exp_f32 v17, v17
    v_exp_f32 v18, v18
    v_smfmac_f32_32x32x32_bf16 v[200:215], v[188:191], v[40:47], v15
    s_mov_b64 exec, s[60:61]
    ds_read_b128 v[184:187], v0 offset:5120
    ds_read_b128 v[188:191], v0 offset:5376
    s_mov_b64 exec, -1
    v_exp_f32 v19, v19
    v_exp_f32 v20, v20
    v_exp_f32 v21, v21
    v_mfma_f32_32x32x16_bf16 v[32:47], v[192:195], v[196:199], 0
    ds_read_b128 v[192:195], v0 offset:4096
    v_exp_f32 v22, v22
    v_exp_f32 v23, v23
    v_exp_f32 v24, v24
    v_exp_f32 v25, v25
    v_smfmac_f32_32x32x32_bf16 v[160:175], v[176:179], v[16:23], v15
    s_add_u32 m0, s62, 114688
    s_add_u32 s98, s55, 131072
    buffer_load_dwordx4 v6, s[28:31], s98 offen lds
    v_exp_f32 v26, v26
    v_exp_f32 v27, v27
    v_exp_f32 v28, v28
    v_exp_f32 v29, v29
    v_exp_f32 v30, v30
    v_exp_f32 v31, v31
    s_setprio 2
    v_exp_f32 v32, v32
    v_exp_f32 v33, v33
    v_exp_f32 v34, v34
    v_smfmac_f32_32x32x32_bf16 v[160:175], v[180:183], v[24:31], v15
    v_exp_f32 v35, v35
    v_exp_f32 v36, v36
    v_exp_f32 v37, v37
    s_waitcnt lgkmcnt(0)
    v_mfma_f32_32x32x16_bf16 v[16:31], v[192:195], v[120:123], 0
    v_exp_f32 v38, v38
    v_exp_f32 v39, v39
    v_exp_f32 v40, v40
    v_exp_f32 v41, v41
    v_smfmac_f32_32x32x32_bf16 v[200:215], v[176:179], v[32:39], v15
    s_add_u32 m0, s62, 122880
    s_add_u32 s98, s55, 196608
    buffer_load_dwordx4 v6, s[28:31], s98 offen lds
    v_exp_f32 v42, v42
    v_exp_f32 v43, v43
    v_exp_f32 v44, v44
    v_exp_f32 v45, v45
    v_exp_f32 v46, v46
    v_exp_f32 v47, v47
    s_setprio 1
    v_exp_f32 v16, v16
    v_exp_f32 v17, v17
    v_exp_f32 v18, v18
    v_smfmac_f32_32x32x32_bf16 v[200:215], v[180:183], v[40:47], v15
    s_mov_b64 exec, s[60:61]
    ds_read_b128 v[176:179], v0 offset:9216
    ds_read_b128 v[180:183], v0 offset:9472
    s_mov_b64 exec, -1
    v_exp_f32 v19, v19
    v_exp_f32 v20, v20
    v_exp_f32 v21, v21
    v_mfma_f32_32x32x16_bf16 v[32:47], v[192:195], v[196:199], 0
    ds_read_b128 v[192:195], v0 offset:8192
    v_exp_f32 v22, v22
    v_exp_f32 v23, v23
    v_exp_f32 v24, v24
    v_exp_f32 v25, v25
    v_smfmac_f32_32x32x32_bf16 v[160:175], v[184:187], v[16:23], v15
    s_add_u32 m0, s62, 131072
    s_add_u32 s98, s55, 262144
    buffer_load_dwordx4 v6, s[28:31], s98 offen lds
    v_exp_f32 v26, v26
    v_exp_f32 v27, v27
    v_exp_f32 v28, v28
    v_exp_f32 v29, v29
    v_exp_f32 v30, v30
    v_exp_f32 v31, v31
    s_setprio 0
    v_exp_f32 v32, v32
    v_exp_f32 v33, v33
    v_exp_f32 v34, v34
    v_smfmac_f32_32x32x32_bf16 v[160:175], v[188:191], v[24:31], v15
    v_exp_f32 v35, v35
    v_exp_f32 v36, v36
    v_exp_f32 v37, v37
    s_waitcnt lgkmcnt(0)
    v_mfma_f32_32x32x16_bf16 v[16:31], v[192:195], v[120:123], 0
    v_exp_f32 v38, v38
    v_exp_f32 v39, v39
    v_exp_f32 v40, v40
    v_exp_f32 v41, v41
    v_smfmac_f32_32x32x32_bf16 v[200:215], v[184:187], v[32:39], v15
    s_add_u32 m0, s62, 139264
    s_add_u32 s98, s55, 327680
    buffer_load_dwordx4 v6, s[28:31], s98 offen lds
    v_exp_f32 v42, v42
    v_exp_f32 v43, v43
    v_exp_f32 v44, v44
    v_exp_f32 v45, v45
    v_exp_f32 v46, v46
    v_exp_f32 v47, v47
    s_setprio 3
    v_exp_f32 v16, v16
    v_exp_f32 v17, v17
    v_exp_f32 v18, v18
    v_smfmac_f32_32x32x32_bf16 v[200:215], v[188:191], v[40:47], v15
    s_mov_b64 exec, s[60:61]
    ds_read_b128 v[184:187], v0 offset:13312
    ds_read_b128 v[188:191], v0 offset:13568
    s_mov_b64 exec, -1
    v_exp_f32 v19, v19
    v_exp_f32 v20, v20
    v_exp_f32 v21, v21
    v_mfma_f32_32x32x16_bf16 v[32:47], v[192:195], v[196:199], 0
    ds_read_b128 v[192:195], v0 offset:12288
    v_exp_f32 v22, v22
    v_exp_f32 v23, v23
    v_exp_f32 v24, v24
    v_exp_f32 v25, v25
    v_smfmac_f32_32x32x32_bf16 v[160:175], v[176:179], v[16:23], v15
    s_add_u32 m0, s62, 147456
    s_add_u32 s98, s55, 393216
    buffer_load_dwordx4 v6, s[28:31], s98 offen lds
    v_exp_f32 v26, v26
    v_exp_f32 v27, v27
    v_exp_f32 v28, v28
    v_exp_f32 v29, v29
    v_exp_f32 v30, v30
    v_exp_f32 v31, v31
    s_setprio 2
    v_exp_f32 v32, v32
    v_exp_f32 v33, v33
    v_exp_f32 v34, v34
    v_smfmac_f32_32x32x32_bf16 v[160:175], v[180:183], v[24:31], v15
    v_exp_f32 v35, v35
    v_exp_f32 v36, v36
    v_exp_f32 v37, v37
    s_waitcnt lgkmcnt(0)
    v_mfma_f32_32x32x16_bf16 v[16:31], v[192:195], v[120:123], 0
    v_exp_f32 v38, v38
    v_exp_f32 v39, v39
    v_exp_f32 v40, v40
    v_exp_f32 v41, v41
    v_smfmac_f32_32x32x32_bf16 v[200:215], v[176:179], v[32:39], v15
    s_add_u32 m0, s62, 155648
    s_add_u32 s98, s55, 458752
    buffer_load_dwordx4 v6, s[28:31], s98 offen lds
    v_exp_f32 v42, v42
    v_exp_f32 v43, v43
    v_exp_f32 v44, v44
    v_exp_f32 v45, v45
    v_exp_f32 v46, v46
    v_exp_f32 v47, v47
    s_setprio 1
    v_exp_f32 v16, v16
    v_exp_f32 v17, v17
    v_exp_f32 v18, v18
    v_smfmac_f32_32x32x32_bf16 v[200:215], v[180:183], v[40:47], v15
    s_mov_b64 exec, s[60:61]
    ds_read_b128 v[176:179], v0 offset:17408
    ds_read_b128 v[180:183], v0 offset:17664
    s_mov_b64 exec, -1
    v_exp_f32 v19, v19
    v_exp_f32 v20, v20
    v_exp_f32 v21, v21
    v_mfma_f32_32x32x16_bf16 v[32:47], v[192:195], v[196:199], 0
    ds_read_b128 v[192:195], v0 offset:16384
    v_exp_f32 v22, v22
    v_exp_f32 v23, v23
    v_exp_f32 v24, v24
    v_exp_f32 v25, v25
    v_smfmac_f32_32x32x32_bf16 v[160:175], v[184:187], v[16:23], v15
    v_and_b32 v11, 31, v2
    v_lshlrev_b32 v13, 6, v2
    s_lshr_b32 s66, s69, 1
    s_lshl_b32 s66, s66, 12
    s_add_u32 s66, s66, 327680
    buffer_load_dword v12, v13, s[40:43], s66 offen sc1
    v_exp_f32 v26, v26
    v_exp_f32 v27, v27
    v_exp_f32 v28, v28
    v_exp_f32 v29, v29
    v_exp_f32 v30, v30
    v_exp_f32 v31, v31
    s_setprio 0
    v_exp_f32 v32, v32
    v_exp_f32 v33, v33
    v_exp_f32 v34, v34
    v_smfmac_f32_32x32x32_bf16 v[160:175], v[188:191], v[24:31], v15
    v_exp_f32 v35, v35
    v_exp_f32 v36, v36
    v_exp_f32 v37, v37
    s_waitcnt lgkmcnt(0)
    v_mfma_f32_32x32x16_bf16 v[16:31], v[192:195], v[120:123], 0
    v_exp_f32 v38, v38
    v_exp_f32 v39, v39
    v_exp_f32 v40, v40
    v_exp_f32 v41, v41
    v_smfmac_f32_32x32x32_bf16 v[200:215], v[184:187], v[32:39], v15
    v_exp_f32 v42, v42
    v_exp_f32 v43, v43
    v_exp_f32 v44, v44
    v_exp_f32 v45, v45
    v_exp_f32 v46, v46
    v_exp_f32 v47, v47
    s_setprio 3
    v_exp_f32 v16, v16
    v_exp_f32 v17, v17
    v_exp_f32 v18, v18
    v_smfmac_f32_32x32x32_bf16 v[200:215], v[188:191], v[40:47], v15
    s_mov_b64 exec, s[60:61]
    ds_read_b128 v[184:187], v0 offset:21504
    ds_read_b128 v[188:191], v0 offset:21760
    s_mov_b64 exec, -1
    v_exp_f32 v19, v19
    v_exp_f32 v20, v20
    v_exp_f32 v21, v21
    v_mfma_f32_32x32x16_bf16 v[32:47], v[192:195], v[196:199], 0
    ds_read_b128 v[192:195], v0 offset:20480
    v_exp_f32 v22, v22
    v_exp_f32 v23, v23
    v_exp_f32 v24, v24
    v_exp_f32 v25, v25
    v_smfmac_f32_32x32x32_bf16 v[160:175], v[176:179], v[16:23], v15
    v_exp_f32 v26, v26
    v_exp_f32 v27, v27
    v_exp_f32 v28, v28
    v_exp_f32 v29, v29
    v_exp_f32 v30, v30
    v_exp_f32 v31, v31
    s_waitcnt vmcnt(0)
    v_cmp_ne_u32 vcc, s49, v12
    s_nop 0
    s_cbranch_vccnz L_hp_f
L_hp_f_r:
    s_setprio 2
    v_exp_f32 v32, v32
    v_exp_f32 v33, v33
    v_exp_f32 v34, v34
    v_smfmac_f32_32x32x32_bf16 v[160:175], v[180:183], v[24:31], v15
    v_exp_f32 v35, v35
    v_exp_f32 v36, v36
    v_exp_f32 v37, v37
    s_waitcnt lgkmcnt(0)
    v_mfma_f32_32x32x16_bf16 v[16:31], v[192:195], v[120:123], 0
    v_exp_f32 v38, v38
    v_exp_f32 v39, v39
    v_exp_f32 v40, v40
    v_exp_f32 v41, v41
    v_smfmac_f32_32x32x32_bf16 v[200:215], v[176:179], v[32:39], v15
    v_lshlrev_b32 v11, 2, v11
    s_lshl_b32 s99, s69, 7
    s_add_u32 s99, s99, 131072
    buffer_load_dword v126, v11, s[40:43], s99 offen sc1
    s_lshl_b32 s99, s47, 9
    s_lshl_b32 s100, s46, 7
    s_add_u32 s99, s99, s100
    s_add_u32 s99, s99, 131072
    buffer_load_dword v124, v11, s[40:43], s99 offen sc1
    s_lshr_b32 s100, s44, 1
    s_lshl_b32 s66, s100, 12
    s_add_u32 s66, s66, s68
    v_exp_f32 v42, v42
    v_exp_f32 v43, v43
    v_exp_f32 v44, v44
    v_exp_f32 v45, v45
    v_exp_f32 v46, v46
    v_exp_f32 v47, v47
    s_setprio 1
    v_exp_f32 v16, v16
    v_exp_f32 v17, v17
    v_exp_f32 v18, v18
    v_smfmac_f32_32x32x32_bf16 v[200:215], v[180:183], v[40:47], v15
    s_mov_b64 exec, s[60:61]
    ds_read_b128 v[176:179], v0 offset:25600
    ds_read_b128 v[180:183], v0 offset:25856
    s_mov_b64 exec, -1
    v_exp_f32 v19, v19
    v_exp_f32 v20, v20
    v_exp_f32 v21, v21
    v_mfma_f32_32x32x16_bf16 v[32:47], v[192:195], v[196:199], 0
    ds_read_b128 v[192:195], v0 offset:24576
    v_exp_f32 v22, v22
    v_exp_f32 v23, v23
    v_exp_f32 v24, v24
    v_exp_f32 v25, v25
    v_smfmac_f32_32x32x32_bf16 v[160:175], v[184:187], v[16:23], v15
    buffer_load_dwordx4 v[48:51], v3, s[40:43], s66 offen offset:0 sc1
    v_exp_f32 v26, v26
    v_exp_f32 v27, v27
    v_exp_f32 v28, v28
    v_exp_f32 v29, v29
    v_exp_f32 v30, v30
    v_exp_f32 v31, v31
    s_setprio 0
    v_exp_f32 v32, v32
    v_exp_f32 v33, v33
    v_exp_f32 v34, v34
    v_smfmac_f32_32x32x32_bf16 v[160:175], v[188:191], v[24:31], v15
    v_exp_f32 v35, v35
    v_exp_f32 v36, v36
    v_exp_f32 v37, v37
    s_waitcnt lgkmcnt(0)
    v_mfma_f32_32x32x16_bf16 v[16:31], v[192:195], v[120:123], 0
    v_exp_f32 v38, v38
    v_exp_f32 v39, v39
    v_exp_f32 v40, v40
    v_exp_f32 v41, v41
    v_smfmac_f32_32x32x32_bf16 v[200:215], v[184:187], v[32:39], v15
    buffer_load_dwordx4 v[52:55], v3, s[40:43], s66 offen offset:1024 sc1
    v_exp_f32 v42, v42
    v_exp_f32 v43, v43
    v_exp_f32 v44, v44
    v_exp_f32 v45, v45
    v_exp_f32 v46, v46
    v_exp_f32 v47, v47
    s_setprio 3
    v_exp_f32 v16, v16
    v_exp_f32 v17, v17
    v_exp_f32 v18, v18
    v_smfmac_f32_32x32x32_bf16 v[200:215], v[188:191], v[40:47], v15
    s_mov_b64 exec, s[60:61]
    ds_read_b128 v[184:187], v0 offset:29696
    ds_read_b128 v[188:191], v0 offset:29952
    s_mov_b64 exec, -1
    v_exp_f32 v19, v19
    v_exp_f32 v20, v20
    v_exp_f32 v21, v21
    v_mfma_f32_32x32x16_bf16 v[32:47], v[192:195], v[196:199], 0
    ds_read_b128 v[192:195], v0 offset:28672
    v_exp_f32 v22, v22
    v_exp_f32 v23, v23
    v_exp_f32 v24, v24
    v_exp_f32 v25, v25
    v_smfmac_f32_32x32x32_bf16 v[160:175], v[176:179], v[16:23], v15
    buffer_load_dwordx4 v[56:59], v3, s[40:43], s66 offen offset:2048 sc1
    v_exp_f32 v26, v26
    v_exp_f32 v27, v27
    v_exp_f32 v28, v28
    v_exp_f32 v29, v29
    v_exp_f32 v30, v30
    v_exp_f32 v31, v31
    s_setprio 2
    v_exp_f32 v32, v32
    v_exp_f32 v33, v33
    v_exp_f32 v34, v34
    v_smfmac_f32_32x32x32_bf16 v[160:175], v[180:183], v[24:31], v15
    v_exp_f32 v35, v35
    v_exp_f32 v36, v36
    v_exp_f32 v37, v37
    s_waitcnt lgkmcnt(0)
    v_mfma_f32_32x32x16_bf16 v[16:31], v[192:195], v[120:123], 0
    v_exp_f32 v38, v38
    v_exp_f32 v39, v39
    v_exp_f32 v40, v40
    v_exp_f32 v41, v41
    v_smfmac_f32_32x32x32_bf16 v[200:215], v[176:179], v[32:39], v15
    buffer_load_dwordx4 v[60:63], v3, s[40:43], s66 offen offset:3072 sc1
    v_exp_f32 v42, v42
    v_exp_f32 v43, v43
    v_exp_f32 v44, v44
    v_exp_f32 v45, v45
    v_exp_f32 v46, v46
    v_exp_f32 v47, v47
    s_setprio 1
    v_exp_f32 v16, v16
    v_exp_f32 v17, v17
    v_exp_f32 v18, v18
    v_smfmac_f32_32x32x32_bf16 v[200:215], v[180:183], v[40:47], v15
    s_mov_b64 exec, s[60:61]
    ds_read_b128 v[176:179], v0 offset:33792
    ds_read_b128 v[180:183], v0 offset:34048
    s_mov_b64 exec, -1
    v_exp_f32 v19, v19
    v_exp_f32 v20, v20
    v_exp_f32 v21, v21
    v_mfma_f32_32x32x16_bf16 v[32:47], v[192:195], v[196:199], 0
    ds_read_b128 v[192:195], v0 offset:32768
    v_exp_f32 v22, v22
    v_exp_f32 v23, v23
    v_exp_f32 v24, v24
    v_exp_f32 v25, v25
    v_smfmac_f32_32x32x32_bf16 v[160:175], v[184:187], v[16:23], v15
    s_add_u32 s66, s66, 16384
    buffer_load_dwordx4 v[64:67], v3, s[40:43], s66 offen offset:0 sc1
    v_exp_f32 v26, v26
    v_exp_f32 v27, v27
    v_exp_f32 v28, v28
    v_exp_f32 v29, v29
    v_exp_f32 v30, v30
    v_exp_f32 v31, v31
    s_setprio 0
    v_exp_f32 v32, v32
    v_exp_f32 v33, v33
    v_exp_f32 v34, v34
    v_smfmac_f32_32x32x32_bf16 v[160:175], v[188:191], v[24:31], v15
    v_exp_f32 v35, v35
    v_exp_f32 v36, v36
    v_exp_f32 v37, v37
    s_waitcnt lgkmcnt(0)
    v_mfma_f32_32x32x16_bf16 v[16:31], v[192:195], v[120:123], 0
    v_exp_f32 v38, v38
    v_exp_f32 v39, v39
    v_exp_f32 v40, v40
    v_exp_f32 v41, v41
    v_smfmac_f32_32x32x32_bf16 v[200:215], v[184:187], v[32:39], v15
    buffer_load_dwordx4 v[68:71], v3, s[40:43], s66 offen offset:1024 sc1
    v_exp_f32 v42, v42
    v_exp_f32 v43, v43
    v_exp_f32 v44, v44
    v_exp_f32 v45, v45
    v_exp_f32 v46, v46
    v_exp_f32 v47, v47
    s_setprio 3
    v_exp_f32 v16, v16
    v_exp_f32 v17, v17
    v_exp_f32 v18, v18
    v_smfmac_f32_32x32x32_bf16 v[200:215], v[188:191], v[40:47], v15
    s_mov_b64 exec, s[60:61]
    ds_read_b128 v[184:187], v0 offset:37888
    ds_read_b128 v[188:191], v0 offset:38144
    s_mov_b64 exec, -1
    v_exp_f32 v19, v19
    v_exp_f32 v20, v20
    v_exp_f32 v21, v21
    v_mfma_f32_32x32x16_bf16 v[32:47], v[192:195], v[196:199], 0
    ds_read_b128 v[192:195], v0 offset:36864
    v_exp_f32 v22, v22
    v_exp_f32 v23, v23
    v_exp_f32 v24, v24
    v_exp_f32 v25, v25
    v_smfmac_f32_32x32x32_bf16 v[160:175], v[176:179], v[16:23], v15
    buffer_load_dwordx4 v[72:75], v3, s[40:43], s66 offen offset:2048 sc1
    v_exp_f32 v26, v26
    v_exp_f32 v27, v27
    v_exp_f32 v28, v28
    v_exp_f32 v29, v29
    v_exp_f32 v30, v30
    v_exp_f32 v31, v31
    s_setprio 2
    v_exp_f32 v32, v32
    v_exp_f32 v33, v33
    v_exp_f32 v34, v34
    v_smfmac_f32_32x32x32_bf16 v[160:175], v[180:183], v[24:31], v15
    v_exp_f32 v35, v35
    v_exp_f32 v36, v36
    v_exp_f32 v37, v37
    s_waitcnt lgkmcnt(0)
    v_mfma_f32_32x32x16_bf16 v[16:31], v[192:195], v[120:123], 0
    v_exp_f32 v38, v38
    v_exp_f32 v39, v39
    v_exp_f32 v40, v40
    v_exp_f32 v41, v41
    v_smfmac_f32_32x32x32_bf16 v[200:215], v[176:179], v[32:39], v15
    buffer_load_dwordx4 v[76:79], v3, s[40:43], s66 offen offset:3072 sc1
    v_exp_f32 v42, v42
    v_exp_f32 v43, v43
    v_exp_f32 v44, v44
    v_exp_f32 v45, v45
    v_exp_f32 v46, v46
    v_exp_f32 v47, v47
    s_waitcnt vmcnt(8)
    s_mov_b32 s101, 1069066811
    v_mul_f32 v126, s101, v126
    v_mul_f32 v124, s101, v124
    v_exp_f32 v126, v126
    v_exp_f32 v124, -v124
    v_add_f32 v126, 1.0, v126
    v_add_f32 v124, 1.0, v124
    v_rcp_f32 v126, v126
    v_rcp_f32 v124, v124
    v_add_u32 v8, 98304, v5
    v_xor_b32 v9, 64, v8
    s_setprio 1
    v_exp_f32 v16, v16
    v_exp_f32 v17, v17
    v_exp_f32 v18, v18
    v_smfmac_f32_32x32x32_bf16 v[200:215], v[180:183], v[40:47], v15
    s_mov_b64 exec, s[60:61]
    ds_read_b128 v[176:179], v0 offset:41984
    ds_read_b128 v[180:183], v0 offset:42240
    s_mov_b64 exec, -1
    v_exp_f32 v19, v19
    v_exp_f32 v20, v20
    v_exp_f32 v21, v21
    v_mfma_f32_32x32x16_bf16 v[32:47], v[192:195], v[196:199], 0
    ds_read_b128 v[192:195], v0 offset:40960
    v_exp_f32 v22, v22
    v_exp_f32 v23, v23
    v_exp_f32 v24, v24
    v_exp_f32 v25, v25
    v_smfmac_f32_32x32x32_bf16 v[160:175], v[184:187], v[16:23], v15
    s_add_u32 s66, s66, 16384
    buffer_load_dwordx4 v[80:83], v3, s[40:43], s66 offen offset:0 sc1
    v_exp_f32 v26, v26
    v_exp_f32 v27, v27
    v_exp_f32 v28, v28
    v_exp_f32 v29, v29
    v_exp_f32 v30, v30
    v_exp_f32 v31, v31
    s_setprio 0
    v_exp_f32 v32, v32
    v_exp_f32 v33, v33
    v_exp_f32 v34, v34
    v_smfmac_f32_32x32x32_bf16 v[160:175], v[188:191], v[24:31], v15
    v_exp_f32 v35, v35
    v_exp_f32 v36, v36
    v_exp_f32 v37, v37
    s_waitcnt lgkmcnt(0)
    v_mfma_f32_32x32x16_bf16 v[16:31], v[192:195], v[120:123], 0
    v_exp_f32 v38, v38
    v_exp_f32 v39, v39
    v_exp_f32 v40, v40
    v_exp_f32 v41, v41
    v_smfmac_f32_32x32x32_bf16 v[200:215], v[184:187], v[32:39], v15
    buffer_load_dwordx4 v[84:87], v3, s[40:43], s66 offen offset:1024 sc1
    v_exp_f32 v42, v42
    v_exp_f32 v43, v43
    v_exp_f32 v44, v44
    v_exp_f32 v45, v45
    v_exp_f32 v46, v46
    v_exp_f32 v47, v47
    s_setprio 3
    v_exp_f32 v16, v16
    v_exp_f32 v17, v17
    v_exp_f32 v18, v18
    v_smfmac_f32_32x32x32_bf16 v[200:215], v[188:191], v[40:47], v15
    s_mov_b64 exec, s[60:61]
    ds_read_b128 v[184:187], v0 offset:46080
    ds_read_b128 v[188:191], v0 offset:46336
    s_mov_b64 exec, -1
    v_exp_f32 v19, v19
    v_exp_f32 v20, v20
    v_exp_f32 v21, v21
    v_mfma_f32_32x32x16_bf16 v[32:47], v[192:195], v[196:199], 0
    ds_read_b128 v[192:195], v0 offset:45056
    v_exp_f32 v22, v22
    v_exp_f32 v23, v23
    v_exp_f32 v24, v24
    v_exp_f32 v25, v25
    v_smfmac_f32_32x32x32_bf16 v[160:175], v[176:179], v[16:23], v15
    buffer_load_dwordx4 v[88:91], v3, s[40:43], s66 offen offset:2048 sc1
    v_exp_f32 v26, v26
    v_exp_f32 v27, v27
    v_exp_f32 v28, v28
    v_exp_f32 v29, v29
    v_exp_f32 v30, v30
    v_exp_f32 v31, v31
    s_setprio 2
    v_exp_f32 v32, v32
    v_exp_f32 v33, v33
    v_exp_f32 v34, v34
    v_smfmac_f32_32x32x32_bf16 v[160:175], v[180:183], v[24:31], v15
    v_exp_f32 v35, v35
    v_exp_f32 v36, v36
    v_exp_f32 v37, v37
    s_waitcnt lgkmcnt(0)
    v_mfma_f32_32x32x16_bf16 v[16:31], v[192:195], v[120:123], 0
    v_exp_f32 v38, v38
    v_exp_f32 v39, v39
    v_exp_f32 v40, v40
    v_exp_f32 v41, v41
    v_smfmac_f32_32x32x32_bf16 v[200:215], v[176:179], v[32:39], v15
    buffer_load_dwordx4 v[92:95], v3, s[40:43], s66 offen offset:3072 sc1
    v_exp_f32 v42, v42
    v_exp_f32 v43, v43
    v_exp_f32 v44, v44
    v_exp_f32 v45, v45
    v_exp_f32 v46, v46
    v_exp_f32 v47, v47
    s_setprio 1
    v_exp_f32 v16, v16
    v_exp_f32 v17, v17
    v_exp_f32 v18, v18
    v_smfmac_f32_32x32x32_bf16 v[200:215], v[180:183], v[40:47], v15
    s_mov_b64 exec, s[60:61]
    ds_read_b128 v[176:179], v0 offset:50176
    ds_read_b128 v[180:183], v0 offset:50432
    s_mov_b64 exec, -1
    v_exp_f32 v19, v19
    v_exp_f32 v20, v20
    v_exp_f32 v21, v21
    v_mfma_f32_32x32x16_bf16 v[32:47], v[192:195], v[196:199], 0
    ds_read_b128 v[192:195], v0 offset:49152
    v_exp_f32 v22, v22
    v_exp_f32 v23, v23
    v_exp_f32 v24, v24
    v_exp_f32 v25, v25
    v_smfmac_f32_32x32x32_bf16 v[160:175], v[184:187], v[16:23], v15
    s_add_u32 s66, s66, 16384
    buffer_load_dwordx4 v[96:99], v3, s[40:43], s66 offen offset:0 sc1
    v_exp_f32 v26, v26
    v_exp_f32 v27, v27
    v_exp_f32 v28, v28
    v_exp_f32 v29, v29
    v_exp_f32 v30, v30
    v_exp_f32 v31, v31
    s_setprio 0
    v_exp_f32 v32, v32
    v_exp_f32 v33, v33
    v_exp_f32 v34, v34
    v_smfmac_f32_32x32x32_bf16 v[160:175], v[188:191], v[24:31], v15
    v_exp_f32 v35, v35
    v_exp_f32 v36, v36
    v_exp_f32 v37, v37
    s_waitcnt lgkmcnt(0)
    v_mfma_f32_32x32x16_bf16 v[16:31], v[192:195], v[120:123], 0
    v_exp_f32 v38, v38
    v_exp_f32 v39, v39
    v_exp_f32 v40, v40
    v_exp_f32 v41, v41
    v_smfmac_f32_32x32x32_bf16 v[200:215], v[184:187], v[32:39], v15
    buffer_load_dwordx4 v[100:103], v3, s[40:43], s66 offen offset:1024 sc1
    v_exp_f32 v42, v42
    v_exp_f32 v43, v43
    v_exp_f32 v44, v44
    v_exp_f32 v45, v45
    v_exp_f32 v46, v46
    v_exp_f32 v47, v47
    s_setprio 3
    v_exp_f32 v16, v16
    v_exp_f32 v17, v17
    v_exp_f32 v18, v18
    v_smfmac_f32_32x32x32_bf16 v[200:215], v[188:191], v[40:47], v15
    s_mov_b64 exec, s[60:61]
    ds_read_b128 v[184:187], v0 offset:54272
    ds_read_b128 v[188:191], v0 offset:54528
    s_mov_b64 exec, -1
    v_exp_f32 v19, v19
    v_exp_f32 v20, v20
    v_exp_f32 v21, v21
    v_mfma_f32_32x32x16_bf16 v[32:47], v[192:195], v[196:199], 0
    ds_read_b128 v[192:195], v0 offset:53248
    v_exp_f32 v22, v22
    v_exp_f32 v23, v23
    v_exp_f32 v24, v24
    v_exp_f32 v25, v25
    v_smfmac_f32_32x32x32_bf16 v[160:175], v[176:179], v[16:23], v15
    buffer_load_dwordx4 v[104:107], v3, s[40:43], s66 offen offset:2048 sc1
    v_exp_f32 v26, v26
    v_exp_f32 v27, v27
    v_exp_f32 v28, v28
    v_exp_f32 v29, v29
    v_exp_f32 v30, v30
    v_exp_f32 v31, v31
    s_setprio 2
    v_exp_f32 v32, v32
    v_exp_f32 v33, v33
    v_exp_f32 v34, v34
    v_smfmac_f32_32x32x32_bf16 v[160:175], v[180:183], v[24:31], v15
    v_exp_f32 v35, v35
    v_exp_f32 v36, v36
    v_exp_f32 v37, v37
    s_waitcnt lgkmcnt(0)
    v_mfma_f32_32x32x16_bf16 v[16:31], v[192:195], v[120:123], 0
    v_exp_f32 v38, v38
    v_exp_f32 v39, v39
    v_exp_f32 v40, v40
    v_exp_f32 v41, v41
    v_smfmac_f32_32x32x32_bf16 v[200:215], v[176:179], v[32:39], v15
    buffer_load_dwordx4 v[108:111], v3, s[40:43], s66 offen offset:3072 sc1
    v_exp_f32 v42, v42
    v_exp_f32 v43, v43
    v_exp_f32 v44, v44
    v_exp_f32 v45, v45
    v_exp_f32 v46, v46
    v_exp_f32 v47, v47
    s_setprio 1
    v_exp_f32 v16, v16
    v_exp_f32 v17, v17
    v_exp_f32 v18, v18
    v_smfmac_f32_32x32x32_bf16 v[200:215], v[180:183], v[40:47], v15
    s_mov_b64 exec, s[60:61]
    ds_read_b128 v[176:179], v0 offset:58368
    ds_read_b128 v[180:183], v0 offset:58624
    s_mov_b64 exec, -1
    v_exp_f32 v19, v19
    v_exp_f32 v20, v20
    v_exp_f32 v21, v21
    v_mfma_f32_32x32x16_bf16 v[32:47], v[192:195], v[196:199], 0
    ds_read_b128 v[192:195], v0 offset:57344
    v_exp_f32 v22, v22
    v_exp_f32 v23, v23
    v_exp_f32 v24, v24
    v_exp_f32 v25, v25
    v_smfmac_f32_32x32x32_bf16 v[160:175], v[184:187], v[16:23], v15
    s_add_u32 s66, s66, 16384
    buffer_load_dwordx4 v[112:115], v3, s[40:43], s66 offen offset:0 sc1
    v_exp_f32 v26, v26
    v_exp_f32 v27, v27
    v_exp_f32 v28, v28
    v_exp_f32 v29, v29
    v_exp_f32 v30, v30
    v_exp_f32 v31, v31
    s_setprio 0
    v_exp_f32 v32, v32
    v_exp_f32 v33, v33
    v_exp_f32 v34, v34
    v_smfmac_f32_32x32x32_bf16 v[160:175], v[188:191], v[24:31], v15
    v_exp_f32 v35, v35
    v_exp_f32 v36, v36
    v_exp_f32 v37, v37
    s_waitcnt lgkmcnt(0)
    v_mfma_f32_32x32x16_bf16 v[16:31], v[192:195], v[120:123], 0
    v_exp_f32 v38, v38
    v_exp_f32 v39, v39
    v_exp_f32 v40, v40
    v_exp_f32 v41, v41
    v_smfmac_f32_32x32x32_bf16 v[200:215], v[184:187], v[32:39], v15
    buffer_load_dwordx4 v[116:119], v3, s[40:43], s66 offen offset:1024 sc1
    v_exp_f32 v42, v42
    v_exp_f32 v43, v43
    v_exp_f32 v44, v44
    v_exp_f32 v45, v45
    v_exp_f32 v46, v46
    v_exp_f32 v47, v47
    s_setprio 3
    v_exp_f32 v16, v16
    v_exp_f32 v17, v17
    v_exp_f32 v18, v18
    v_smfmac_f32_32x32x32_bf16 v[200:215], v[188:191], v[40:47], v15
    s_mov_b64 exec, s[60:61]
    ds_read_b128 v[184:187], v0 offset:62464
    ds_read_b128 v[188:191], v0 offset:62720
    s_mov_b64 exec, -1
    v_exp_f32 v19, v19
    v_exp_f32 v20, v20
    v_exp_f32 v21, v21
    v_mfma_f32_32x32x16_bf16 v[32:47], v[192:195], v[196:199], 0
    ds_read_b128 v[192:195], v0 offset:61440
    v_exp_f32 v22, v22
    v_exp_f32 v23, v23
    v_exp_f32 v24, v24
    v_exp_f32 v25, v25
    v_smfmac_f32_32x32x32_bf16 v[160:175], v[176:179], v[16:23], v15
    buffer_load_dwordx4 v[216:219], v3, s[40:43], s66 offen offset:2048 sc1
    v_exp_f32 v26, v26
    v_exp_f32 v27, v27
    v_exp_f32 v28, v28
    v_exp_f32 v29, v29
    v_exp_f32 v30, v30
    v_exp_f32 v31, v31
    s_setprio 2
    v_exp_f32 v32, v32
    v_exp_f32 v33, v33
    v_exp_f32 v34, v34
    v_smfmac_f32_32x32x32_bf16 v[160:175], v[180:183], v[24:31], v15
    v_exp_f32 v35, v35
    v_exp_f32 v36, v36
    v_exp_f32 v37, v37
    s_waitcnt lgkmcnt(0)
    v_mfma_f32_32x32x16_bf16 v[16:31], v[192:195], v[120:123], 0
    v_exp_f32 v38, v38
    v_exp_f32 v39, v39
    v_exp_f32 v40, v40
    v_exp_f32 v41, v41
    v_smfmac_f32_32x32x32_bf16 v[200:215], v[176:179], v[32:39], v15
    buffer_load_dwordx4 v[220:223], v3, s[40:43], s66 offen offset:3072 sc1
    v_exp_f32 v42, v42
    v_exp_f32 v43, v43
    v_exp_f32 v44, v44
    v_exp_f32 v45, v45
    v_exp_f32 v46, v46
    v_exp_f32 v47, v47
    s_setprio 1
    v_exp_f32 v16, v16
    v_exp_f32 v17, v17
    v_exp_f32 v18, v18
    v_smfmac_f32_32x32x32_bf16 v[200:215], v[180:183], v[40:47], v15
    s_mov_b64 exec, s[60:61]
    ds_read_b128 v[176:179], v1 offset:1024
    ds_read_b128 v[180:183], v1 offset:1280
    s_mov_b64 exec, -1
    v_exp_f32 v19, v19
    v_exp_f32 v20, v20
    v_exp_f32 v21, v21
    v_mfma_f32_32x32x16_bf16 v[32:47], v[192:195], v[196:199], 0
    ds_read_b128 v[192:195], v1 offset:0
    v_exp_f32 v22, v22
    v_exp_f32 v23, v23
    v_exp_f32 v24, v24
    v_exp_f32 v25, v25
    v_smfmac_f32_32x32x32_bf16 v[160:175], v[184:187], v[16:23], v15
    s_add_u32 s66, s66, 16384
    buffer_load_dwordx4 v[224:227], v3, s[40:43], s66 offen offset:0 sc1
    v_exp_f32 v26, v26
    v_exp_f32 v27, v27
    v_exp_f32 v28, v28
    v_exp_f32 v29, v29
    v_exp_f32 v30, v30
    v_exp_f32 v31, v31
    s_setprio 0
    v_exp_f32 v32, v32
    v_exp_f32 v33, v33
    v_exp_f32 v34, v34
    v_smfmac_f32_32x32x32_bf16 v[160:175], v[188:191], v[24:31], v15
    v_exp_f32 v35, v35
    v_exp_f32 v36, v36
    v_exp_f32 v37, v37
    s_waitcnt lgkmcnt(0)
    v_mfma_f32_32x32x16_bf16 v[16:31], v[192:195], v[120:123], 0
    v_exp_f32 v38, v38
    v_exp_f32 v39, v39
    v_exp_f32 v40, v40
    v_exp_f32 v41, v41
    v_smfmac_f32_32x32x32_bf16 v[200:215], v[184:187], v[32:39], v15
    buffer_load_dwordx4 v[228:231], v3, s[40:43], s66 offen offset:1024 sc1
    v_exp_f32 v42, v42
    v_exp_f32 v43, v43
    v_exp_f32 v44, v44
    v_exp_f32 v45, v45
    v_exp_f32 v46, v46
    v_exp_f32 v47, v47
    s_setprio 3
    v_exp_f32 v16, v16
    v_exp_f32 v17, v17
    v_exp_f32 v18, v18
    v_smfmac_f32_32x32x32_bf16 v[200:215], v[188:191], v[40:47], v15
    s_mov_b64 exec, s[60:61]
    ds_read_b128 v[184:187], v1 offset:5120
    ds_read_b128 v[188:191], v1 offset:5376
    s_mov_b64 exec, -1
    v_exp_f32 v19, v19
    v_exp_f32 v20, v20
    v_exp_f32 v21, v21
    v_mfma_f32_32x32x16_bf16 v[32:47], v[192:195], v[196:199], 0
    ds_read_b128 v[192:195], v1 offset:4096
    v_exp_f32 v22, v22
    v_exp_f32 v23, v23
    v_exp_f32 v24, v24
    v_exp_f32 v25, v25
    v_smfmac_f32_32x32x32_bf16 v[160:175], v[176:179], v[16:23], v15
    buffer_load_dwordx4 v[232:235], v3, s[40:43], s66 offen offset:2048 sc1
    v_exp_f32 v26, v26
    v_exp_f32 v27, v27
    v_exp_f32 v28, v28
    v_exp_f32 v29, v29
    v_exp_f32 v30, v30
    v_exp_f32 v31, v31
    s_setprio 2
    v_exp_f32 v32, v32
    v_exp_f32 v33, v33
    v_exp_f32 v34, v34
    v_smfmac_f32_32x32x32_bf16 v[160:175], v[180:183], v[24:31], v15
    v_exp_f32 v35, v35
    v_exp_f32 v36, v36
    v_exp_f32 v37, v37
    s_waitcnt lgkmcnt(0)
    v_mfma_f32_32x32x16_bf16 v[16:31], v[192:195], v[120:123], 0
    v_exp_f32 v38, v38
    v_exp_f32 v39, v39
    v_exp_f32 v40, v40
    v_exp_f32 v41, v41
    v_smfmac_f32_32x32x32_bf16 v[200:215], v[176:179], v[32:39], v15
    buffer_load_dwordx4 v[236:239], v3, s[40:43], s66 offen offset:3072 sc1
    v_exp_f32 v42, v42
    v_exp_f32 v43, v43
    v_exp_f32 v44, v44
    v_exp_f32 v45, v45
    v_exp_f32 v46, v46
    v_exp_f32 v47, v47
    s_waitcnt vmcnt(63)
    s_barrier
    s_setprio 1
    v_exp_f32 v16, v16
    v_exp_f32 v17, v17
    v_exp_f32 v18, v18
    v_smfmac_f32_32x32x32_bf16 v[200:215], v[180:183], v[40:47], v15
    s_mov_b64 exec, s[60:61]
    ds_read_b128 v[176:179], v1 offset:9216
    ds_read_b128 v[180:183], v1 offset:9472
    s_mov_b64 exec, -1
    v_exp_f32 v19, v19
    v_exp_f32 v20, v20
    v_exp_f32 v21, v21
    v_mfma_f32_32x32x16_bf16 v[32:47], v[192:195], v[196:199], 0
    ds_read_b128 v[192:195], v1 offset:8192
    v_exp_f32 v22, v22
    v_exp_f32 v23, v23
    v_exp_f32 v24, v24
    v_exp_f32 v25, v25
    v_smfmac_f32_32x32x32_bf16 v[160:175], v[184:187], v[16:23], v15
    s_add_u32 m0, s62, 0
    s_add_u32 s98, s55, 524288
    buffer_load_dwordx4 v6, s[28:31], s98 offen lds
    v_exp_f32 v26, v26
    v_exp_f32 v27, v27
    v_exp_f32 v28, v28
    v_exp_f32 v29, v29
    v_exp_f32 v30, v30
    v_exp_f32 v31, v31
    s_setprio 0
    v_exp_f32 v32, v32
    v_exp_f32 v33, v33
    v_exp_f32 v34, v34
    v_smfmac_f32_32x32x32_bf16 v[160:175], v[188:191], v[24:31], v15
    v_exp_f32 v35, v35
    v_exp_f32 v36, v36
    v_exp_f32 v37, v37
    s_waitcnt lgkmcnt(0)
    v_mfma_f32_32x32x16_bf16 v[16:31], v[192:195], v[120:123], 0
    v_exp_f32 v38, v38
    v_exp_f32 v39, v39
    v_exp_f32 v40, v40
    v_exp_f32 v41, v41
    v_smfmac_f32_32x32x32_bf16 v[200:215], v[184:187], v[32:39], v15
    s_add_u32 m0, s62, 8192
    s_add_u32 s98, s55, 589824
    buffer_load_dwordx4 v6, s[28:31], s98 offen lds
    ds_read_b64_tr_b16 v[128:129], v8 offset:0
    ds_read_b64_tr_b16 v[130:131], v8 offset:1024
    ds_read_b64_tr_b16 v[132:133], v9 offset:0
    ds_read_b64_tr_b16 v[134:135], v9 offset:1024
    v_exp_f32 v42, v42
    v_exp_f32 v43, v43
    v_exp_f32 v44, v44
    v_exp_f32 v45, v45
    v_exp_f32 v46, v46
    v_exp_f32 v47, v47
    s_setprio 3
    v_exp_f32 v16, v16
    v_exp_f32 v17, v17
    v_exp_f32 v18, v18
    v_smfmac_f32_32x32x32_bf16 v[200:215], v[188:191], v[40:47], v15
    s_mov_b64 exec, s[60:61]
    ds_read_b128 v[184:187], v1 offset:13312
    ds_read_b128 v[188:191], v1 offset:13568
    s_mov_b64 exec, -1
    v_exp_f32 v19, v19
    v_exp_f32 v20, v20
    v_exp_f32 v21, v21
    v_mfma_f32_32x32x16_bf16 v[32:47], v[192:195], v[196:199], 0
    ds_read_b128 v[192:195], v1 offset:12288
    v_exp_f32 v22, v22
    v_exp_f32 v23, v23
    v_exp_f32 v24, v24
    v_exp_f32 v25, v25
    v_smfmac_f32_32x32x32_bf16 v[160:175], v[176:179], v[16:23], v15
    s_add_u32 m0, s62, 16384
    s_add_u32 s98, s55, 655360
    buffer_load_dwordx4 v6, s[28:31], s98 offen lds
    ds_read_b64_tr_b16 v[136:137], v8 offset:2048
    ds_read_b64_tr_b16 v[138:139], v8 offset:3072
    ds_read_b64_tr_b16 v[140:141], v9 offset:2048
    ds_read_b64_tr_b16 v[142:143], v9 offset:3072
    v_exp_f32 v26, v26
    v_exp_f32 v27, v27
    v_exp_f32 v28, v28
    v_exp_f32 v29, v29
    v_exp_f32 v30, v30
    v_exp_f32 v31, v31
    s_setprio 2
    v_exp_f32 v32, v32
    v_exp_f32 v33, v33
    v_exp_f32 v34, v34
    v_smfmac_f32_32x32x32_bf16 v[160:175], v[180:183], v[24:31], v15
    v_exp_f32 v35, v35
    v_exp_f32 v36, v36
    v_exp_f32 v37, v37
    s_waitcnt lgkmcnt(0)
    v_mfma_f32_32x32x16_bf16 v[16:31], v[192:195], v[120:123], 0
    v_exp_f32 v38, v38
    v_exp_f32 v39, v39
    v_exp_f32 v40, v40
    v_exp_f32 v41, v41
    v_smfmac_f32_32x32x32_bf16 v[200:215], v[176:179], v[32:39], v15
    s_add_u32 m0, s62, 24576
    s_add_u32 s98, s55, 720896
    buffer_load_dwordx4 v6, s[28:31], s98 offen lds
    ds_read_b64_tr_b16 v[144:145], v8 offset:4096
    ds_read_b64_tr_b16 v[146:147], v8 offset:5120
    ds_read_b64_tr_b16 v[148:149], v9 offset:4096
    ds_read_b64_tr_b16 v[150:151], v9 offset:5120
    v_exp_f32 v42, v42
    v_exp_f32 v43, v43
    v_exp_f32 v44, v44
    v_exp_f32 v45, v45
    v_exp_f32 v46, v46
    v_exp_f32 v47, v47
    s_setprio 1
    v_exp_f32 v16, v16
    v_exp_f32 v17, v17
    v_exp_f32 v18, v18
    v_smfmac_f32_32x32x32_bf16 v[200:215], v[180:183], v[40:47], v15
    s_mov_b64 exec, s[60:61]
    ds_read_b128 v[176:179], v1 offset:17408
    ds_read_b128 v[180:183], v1 offset:17664
    s_mov_b64 exec, -1
    v_exp_f32 v19, v19
    v_exp_f32 v20, v20
    v_exp_f32 v21, v21
    v_mfma_f32_32x32x16_bf16 v[32:47], v[192:195], v[196:199], 0
    ds_read_b128 v[192:195], v1 offset:16384
    v_exp_f32 v22, v22
    v_exp_f32 v23, v23
    v_exp_f32 v24, v24
    v_exp_f32 v25, v25
    v_smfmac_f32_32x32x32_bf16 v[160:175], v[184:187], v[16:23], v15
    s_add_u32 m0, s62, 32768
    s_add_u32 s98, s55, 786432
    buffer_load_dwordx4 v6, s[28:31], s98 offen lds
    ds_read_b64_tr_b16 v[152:153], v8 offset:6144
    ds_read_b64_tr_b16 v[154:155], v8 offset:7168
    ds_read_b64_tr_b16 v[156:157], v9 offset:6144
    ds_read_b64_tr_b16 v[158:159], v9 offset:7168
    v_exp_f32 v26, v26
    v_exp_f32 v27, v27
    v_exp_f32 v28, v28
    v_exp_f32 v29, v29
    v_exp_f32 v30, v30
    v_exp_f32 v31, v31
    s_setprio 0
    v_exp_f32 v32, v32
    v_exp_f32 v33, v33
    v_exp_f32 v34, v34
    v_smfmac_f32_32x32x32_bf16 v[160:175], v[188:191], v[24:31], v15
    v_exp_f32 v35, v35
    v_exp_f32 v36, v36
    v_exp_f32 v37, v37
    s_waitcnt lgkmcnt(0)
    v_mfma_f32_32x32x16_bf16 v[16:31], v[192:195], v[120:123], 0
    v_exp_f32 v38, v38
    v_exp_f32 v39, v39
    v_exp_f32 v40, v40
    v_exp_f32 v41, v41
    v_smfmac_f32_32x32x32_bf16 v[200:215], v[184:187], v[32:39], v15
    s_add_u32 m0, s62, 40960
    s_add_u32 s98, s55, 851968
    buffer_load_dwordx4 v6, s[28:31], s98 offen lds
    v_exp_f32 v42, v42
    v_exp_f32 v43, v43
    v_exp_f32 v44, v44
    v_exp_f32 v45, v45
    v_exp_f32 v46, v46
    v_exp_f32 v47, v47
    s_setprio 3
    v_exp_f32 v16, v16
    v_exp_f32 v17, v17
    v_exp_f32 v18, v18
    v_smfmac_f32_32x32x32_bf16 v[200:215], v[188:191], v[40:47], v15
    s_mov_b64 exec, s[60:61]
    ds_read_b128 v[184:187], v1 offset:21504
    ds_read_b128 v[188:191], v1 offset:21760
    s_mov_b64 exec, -1
    v_exp_f32 v19, v19
    v_exp_f32 v20, v20
    v_exp_f32 v21, v21
    v_mfma_f32_32x32x16_bf16 v[32:47], v[192:195], v[196:199], 0
    ds_read_b128 v[192:195], v1 offset:20480
    v_exp_f32 v22, v22
    v_exp_f32 v23, v23
    v_exp_f32 v24, v24
    v_exp_f32 v25, v25
    v_smfmac_f32_32x32x32_bf16 v[160:175], v[176:179], v[16:23], v15
    s_add_u32 m0, s62, 49152
    s_add_u32 s98, s55, 917504
    buffer_load_dwordx4 v6, s[28:31], s98 offen lds
    v_exp_f32 v26, v26
    v_exp_f32 v27, v27
    v_exp_f32 v28, v28
    v_exp_f32 v29, v29
    v_exp_f32 v30, v30
    v_exp_f32 v31, v31
    s_setprio 2
    v_exp_f32 v32, v32
    v_exp_f32 v33, v33
    v_exp_f32 v34, v34
    v_smfmac_f32_32x32x32_bf16 v[160:175], v[180:183], v[24:31], v15
    v_exp_f32 v35, v35
    v_exp_f32 v36, v36
    v_exp_f32 v37, v37
    s_waitcnt lgkmcnt(0)
    v_mfma_f32_32x32x16_bf16 v[16:31], v[192:195], v[120:123], 0
    v_exp_f32 v38, v38
    v_exp_f32 v39, v39
    v_exp_f32 v40, v40
    v_exp_f32 v41, v41
    v_smfmac_f32_32x32x32_bf16 v[200:215], v[176:179], v[32:39], v15
    s_add_u32 m0, s62, 57344
    s_add_u32 s98, s55, 983040
    buffer_load_dwordx4 v6, s[28:31], s98 offen lds
    v_exp_f32 v42, v42
    v_exp_f32 v43, v43
    v_exp_f32 v44, v44
    v_exp_f32 v45, v45
    v_exp_f32 v46, v46
    v_exp_f32 v47, v47
    s_barrier
    s_setprio 1
    v_exp_f32 v16, v16
    v_exp_f32 v17, v17
    v_exp_f32 v18, v18
    v_smfmac_f32_32x32x32_bf16 v[200:215], v[180:183], v[40:47], v15
    s_mov_b64 exec, s[60:61]
    ds_read_b128 v[176:179], v1 offset:25600
    ds_read_b128 v[180:183], v1 offset:25856
    s_mov_b64 exec, -1
    v_exp_f32 v19, v19
    v_exp_f32 v20, v20
    v_exp_f32 v21, v21
    v_mfma_f32_32x32x16_bf16 v[32:47], v[192:195], v[196:199], 0
    ds_read_b128 v[192:195], v1 offset:24576
    v_exp_f32 v22, v22
    v_exp_f32 v23, v23
    v_exp_f32 v24, v24
    v_exp_f32 v25, v25
    v_smfmac_f32_32x32x32_bf16 v[160:175], v[184:187], v[16:23], v15
    s_add_u32 m0, s62, 98304
    s_add_u32 s98, s55, 1048576
    buffer_load_dwordx4 v6, s[28:31], s98 offen lds
    v_exp_f32 v26, v26
    v_exp_f32 v27, v27
    v_exp_f32 v28, v28
    v_exp_f32 v29, v29
    v_exp_f32 v30, v30
    v_exp_f32 v31, v31
    s_setprio 0
    v_exp_f32 v32, v32
    v_exp_f32 v33, v33
    v_exp_f32 v34, v34
    v_smfmac_f32_32x32x32_bf16 v[160:175], v[188:191], v[24:31], v15
    v_exp_f32 v35, v35
    v_exp_f32 v36, v36
    v_exp_f32 v37, v37
    s_waitcnt lgkmcnt(0)
    v_mfma_f32_32x32x16_bf16 v[16:31], v[192:195], v[120:123], 0
    v_exp_f32 v38, v38
    v_exp_f32 v39, v39
    v_exp_f32 v40, v40
    v_exp_f32 v41, v41
    v_smfmac_f32_32x32x32_bf16 v[200:215], v[184:187], v[32:39], v15
    s_add_u32 m0, s62, 106496
    s_add_u32 s98, s55, 1114112
    buffer_load_dwordx4 v6, s[28:31], s98 offen lds
    v_exp_f32 v42, v42
    v_exp_f32 v43, v43
    v_exp_f32 v44, v44
    v_exp_f32 v45, v45
    v_exp_f32 v46, v46
    v_exp_f32 v47, v47
    s_setprio 3
    v_exp_f32 v16, v16
    v_exp_f32 v17, v17
    v_exp_f32 v18, v18
    v_smfmac_f32_32x32x32_bf16 v[200:215], v[188:191], v[40:47], v15
    s_mov_b64 exec, s[60:61]
    ds_read_b128 v[184:187], v1 offset:29696
    ds_read_b128 v[188:191], v1 offset:29952
    s_mov_b64 exec, -1
    v_exp_f32 v19, v19
    v_exp_f32 v20, v20
    v_exp_f32 v21, v21
    v_mfma_f32_32x32x16_bf16 v[32:47], v[192:195], v[196:199], 0
    ds_read_b128 v[192:195], v1 offset:28672
    v_exp_f32 v22, v22
    v_exp_f32 v23, v23
    v_exp_f32 v24, v24
    v_exp_f32 v25, v25
    v_smfmac_f32_32x32x32_bf16 v[160:175], v[176:179], v[16:23], v15
    s_add_u32 m0, s62, 114688
    s_add_u32 s98, s55, 1179648
    buffer_load_dwordx4 v6, s[28:31], s98 offen lds
    v_exp_f32 v26, v26
    v_exp_f32 v27, v27
    v_exp_f32 v28, v28
    v_exp_f32 v29, v29
    v_exp_f32 v30, v30
    v_exp_f32 v31, v31
    s_setprio 2
    v_exp_f32 v32, v32
    v_exp_f32 v33, v33
    v_exp_f32 v34, v34
    v_smfmac_f32_32x32x32_bf16 v[160:175], v[180:183], v[24:31], v15
    v_exp_f32 v35, v35
    v_exp_f32 v36, v36
    v_exp_f32 v37, v37
    s_waitcnt lgkmcnt(0)
    v_mfma_f32_32x32x16_bf16 v[16:31], v[192:195], v[120:123], 0
    v_exp_f32 v38, v38
    v_exp_f32 v39, v39
    v_exp_f32 v40, v40
    v_exp_f32 v41, v41
    v_smfmac_f32_32x32x32_bf16 v[200:215], v[176:179], v[32:39], v15
    s_add_u32 m0, s62, 122880
    s_add_u32 s98, s55, 1245184
    buffer_load_dwordx4 v6, s[28:31], s98 offen lds
    v_exp_f32 v42, v42
    v_exp_f32 v43, v43
    v_exp_f32 v44, v44
    v_exp_f32 v45, v45
    v_exp_f32 v46, v46
    v_exp_f32 v47, v47
    s_setprio 1
    v_exp_f32 v16, v16
    v_exp_f32 v17, v17
    v_exp_f32 v18, v18
    v_smfmac_f32_32x32x32_bf16 v[200:215], v[180:183], v[40:47], v15
    v_exp_f32 v19, v19
    v_exp_f32 v20, v20
    v_exp_f32 v21, v21
    v_mfma_f32_32x32x16_bf16 v[32:47], v[192:195], v[196:199], 0
    v_exp_f32 v22, v22
    v_exp_f32 v23, v23
    v_exp_f32 v24, v24
    v_exp_f32 v25, v25
    v_smfmac_f32_32x32x32_bf16 v[160:175], v[184:187], v[16:23], v15
    s_add_u32 s66, s66, 16384
    buffer_load_dwordx4 v[240:243], v3, s[40:43], s66 offen offset:0 sc1
    buffer_load_dwordx4 v[244:247], v3, s[40:43], s66 offen offset:1024 sc1
    v_exp_f32 v26, v26
    v_exp_f32 v27, v27
    v_exp_f32 v28, v28
    v_exp_f32 v29, v29
    v_exp_f32 v30, v30
    v_exp_f32 v31, v31
    s_setprio 0
    v_exp_f32 v32, v32
    v_exp_f32 v33, v33
    v_exp_f32 v34, v34
    v_smfmac_f32_32x32x32_bf16 v[160:175], v[188:191], v[24:31], v15
    v_exp_f32 v35, v35
    v_exp_f32 v36, v36
    v_exp_f32 v37, v37
    s_waitcnt lgkmcnt(0)
    v_exp_f32 v38, v38
    v_exp_f32 v39, v39
    v_exp_f32 v40, v40
    v_exp_f32 v41, v41
    v_smfmac_f32_32x32x32_bf16 v[200:215], v[184:187], v[32:39], v15
    buffer_load_dwordx4 v[248:251], v3, s[40:43], s66 offen offset:2048 sc1
    buffer_load_dwordx4 v[252:255], v3, s[40:43], s66 offen offset:3072 sc1
    v_exp_f32 v42, v42
    v_exp_f32 v43, v43
    v_exp_f32 v44, v44
    v_exp_f32 v45, v45
    v_exp_f32 v46, v46
    v_exp_f32 v47, v47
L_tail:
    s_setprio 0
    s_lshr_b32 s101, s44, 1
    v_smfmac_f32_32x32x32_bf16 v[200:215], v[188:191], v[40:47], v15
    s_waitcnt vmcnt(36) lgkmcnt(0)
    v_mfma_f32_32x32x16_bf16 v[16:31], v[128:131], v[48:51], 0
    v_mfma_f32_32x32x16_bf16 v[32:47], v[132:135], v[48:51], 0
    s_mul_i32 s99, s44, 2304
    s_add_u32 s99, s99, 65536
    v_add_u32 v11, s99, v3
    v_lshlrev_b32 v13, 2, v2
    v_add_u32 v12, s99, v13
    s_xor_b32 s99, s44, 4
    s_mul_i32 s99, s99, 2304
    s_add_u32 s99, s99, 65536
    v_mfma_f32_32x32x16_bf16 v[16:31], v[136:139], v[52:55], v[16:31]
    v_mfma_f32_32x32x16_bf16 v[32:47], v[140:143], v[52:55], v[32:47]
    ds_write_b128 v11, v[200:203]
    ds_write_b128 v11, v[204:207] offset:1024
    ds_write_b32 v12, v208 offset:2048
    v_add_u32 v11, s99, v3
    v_add_u32 v12, s99, v13
    s_lshl_b32 s100, s101, 12
    s_add_u32 s100, s100, s68
    s_add_u32 s66, s100, 114688
    s_add_u32 s65, s66, 16384
    v_add_u32 v8, 131072, v5
    v_xor_b32 v9, 64, v8
    s_waitcnt vmcnt(8) lgkmcnt(0)
    s_barrier
    ds_read_b128 v[200:203], v11
    ds_read_b128 v[204:207], v11 offset:1024
    ds_read_b32 v208, v12 offset:2048
    v_mfma_f32_32x32x16_bf16 v[16:31], v[144:147], v[56:59], v[16:31]
    ds_read_b64_tr_b16 v[128:129], v8 offset:0
    ds_read_b64_tr_b16 v[130:131], v8 offset:1024
    ds_read_b64_tr_b16 v[132:133], v9 offset:0
    ds_read_b64_tr_b16 v[134:135], v9 offset:1024
    ds_read_b64_tr_b16 v[136:137], v8 offset:2048
    ds_read_b64_tr_b16 v[138:139], v8 offset:3072
    ds_read_b64_tr_b16 v[140:141], v9 offset:2048
    ds_read_b64_tr_b16 v[142:143], v9 offset:3072
    s_setprio 1
    s_waitcnt lgkmcnt(8)
    v_add_f32 v168, v168, v208
    v_add_f32 v160, v160, v200
    v_add_f32 v161, v161, v201
    v_add_f32 v162, v162, v202
    v_add_f32 v163, v163, v203
    v_rcp_f32 v11, v168
    v_add_f32 v164, v164, v204
    v_add_f32 v165, v165, v205
    v_add_f32 v166, v166, v206
    v_add_f32 v167, v167, v207
    v_mul_f32 v11, v11, v124
    v_mul_f32 v160, v160, v11
    v_mul_f32 v161, v161, v11
    v_mul_f32 v162, v162, v11
    v_mul_f32 v163, v163, v11
    v_mul_f32 v164, v164, v11
    v_mul_f32 v165, v165, v11
    v_mul_f32 v166, v166, v11
    v_mul_f32 v167, v167, v11
    v_cvt_pk_bf16_f32 v168, v160, v161
    v_cvt_pk_bf16_f32 v169, v162, v163
    v_cvt_pk_bf16_f32 v170, v164, v165
    v_cvt_pk_bf16_f32 v171, v166, v167
    v_min_u32 v168, -2, v168
    v_min_u32 v169, -2, v169
    v_min_u32 v170, -2, v170
    v_min_u32 v171, -2, v171
    buffer_store_dwordx4 v[168:171], v3, s[40:43], s57 offen sc1
    s_setprio 0
    v_mfma_f32_32x32x16_bf16 v[32:47], v[148:151], v[56:59], v[32:47]
    v_mfma_f32_32x32x16_bf16 v[16:31], v[152:155], v[60:63], v[16:31]
    v_mfma_f32_32x32x16_bf16 v[32:47], v[156:159], v[60:63], v[32:47]
    ds_read_b64_tr_b16 v[144:145], v8 offset:4096
    ds_read_b64_tr_b16 v[146:147], v8 offset:5120
    ds_read_b64_tr_b16 v[148:149], v9 offset:4096
    ds_read_b64_tr_b16 v[150:151], v9 offset:5120
    s_waitcnt lgkmcnt(8)
    v_mfma_f32_32x32x16_bf16 v[16:31], v[128:131], v[64:67], v[16:31]
    ds_read_b64_tr_b16 v[152:153], v8 offset:6144
    ds_read_b64_tr_b16 v[154:155], v8 offset:7168
    v_mfma_f32_32x32x16_bf16 v[32:47], v[132:135], v[64:67], v[32:47]
    ds_read_b64_tr_b16 v[156:157], v9 offset:6144
    ds_read_b64_tr_b16 v[158:159], v9 offset:7168
    s_waitcnt lgkmcnt(8)
    v_mfma_f32_32x32x16_bf16 v[16:31], v[136:139], v[68:71], v[16:31]
    v_mfma_f32_32x32x16_bf16 v[32:47], v[140:143], v[68:71], v[32:47]
    s_waitcnt vmcnt(5) lgkmcnt(0)
    s_barrier
    v_add_u32 v8, 0, v5
    v_xor_b32 v9, 64, v8
    ds_read_b64_tr_b16 v[128:129], v8 offset:0
    ds_read_b64_tr_b16 v[130:131], v8 offset:1024
    ds_read_b64_tr_b16 v[132:133], v9 offset:0
    ds_read_b64_tr_b16 v[134:135], v9 offset:1024
    s_add_u32 m0, s62, 65536
    s_add_u32 s98, s55, 1310720
    buffer_load_dwordx4 v6, s[28:31], s98 offen lds
    v_mfma_f32_32x32x16_bf16 v[16:31], v[144:147], v[72:75], v[16:31]
    ds_read_b64_tr_b16 v[136:137], v8 offset:2048
    ds_read_b64_tr_b16 v[138:139], v8 offset:3072
    v_mfma_f32_32x32x16_bf16 v[32:47], v[148:151], v[72:75], v[32:47]
    ds_read_b64_tr_b16 v[140:141], v9 offset:2048
    ds_read_b64_tr_b16 v[142:143], v9 offset:3072
    s_add_u32 m0, s62, 73728
    s_add_u32 s98, s55, 1376256
    buffer_load_dwordx4 v6, s[28:31], s98 offen lds
    v_mfma_f32_32x32x16_bf16 v[16:31], v[152:155], v[76:79], v[16:31]
    ds_read_b64_tr_b16 v[144:145], v8 offset:4096
    ds_read_b64_tr_b16 v[146:147], v8 offset:5120
    v_mfma_f32_32x32x16_bf16 v[32:47], v[156:159], v[76:79], v[32:47]
    ds_read_b64_tr_b16 v[148:149], v9 offset:4096
    ds_read_b64_tr_b16 v[150:151], v9 offset:5120
    s_add_u32 m0, s62, 81920
    s_add_u32 s98, s55, 1441792
    buffer_load_dwordx4 v6, s[28:31], s98 offen lds
    s_waitcnt lgkmcnt(8)
    v_mfma_f32_32x32x16_bf16 v[16:31], v[128:131], v[80:83], v[16:31]
    ds_read_b64_tr_b16 v[152:153], v8 offset:6144
    ds_read_b64_tr_b16 v[154:155], v8 offset:7168
    v_mfma_f32_32x32x16_bf16 v[32:47], v[132:135], v[80:83], v[32:47]
    ds_read_b64_tr_b16 v[156:157], v9 offset:6144
    ds_read_b64_tr_b16 v[158:159], v9 offset:7168
    s_add_u32 m0, s62, 90112
    s_add_u32 s98, s55, 1507328
    buffer_load_dwordx4 v6, s[28:31], s98 offen lds
    s_waitcnt lgkmcnt(8)
    v_mfma_f32_32x32x16_bf16 v[16:31], v[136:139], v[84:87], v[16:31]
    v_add_u32 v8, 32768, v5
    v_xor_b32 v9, 64, v8
    ds_read_b64_tr_b16 v[128:129], v8 offset:0
    ds_read_b64_tr_b16 v[130:131], v8 offset:1024
    v_mfma_f32_32x32x16_bf16 v[32:47], v[140:143], v[84:87], v[32:47]
    ds_read_b64_tr_b16 v[132:133], v9 offset:0
    ds_read_b64_tr_b16 v[134:135], v9 offset:1024
    s_add_u32 m0, s62, 131072
    s_add_u32 s98, s55, 1572864
    buffer_load_dwordx4 v6, s[28:31], s98 offen lds
    s_waitcnt lgkmcnt(8)
    v_mfma_f32_32x32x16_bf16 v[16:31], v[144:147], v[88:91], v[16:31]
    ds_read_b64_tr_b16 v[136:137], v8 offset:2048
    ds_read_b64_tr_b16 v[138:139], v8 offset:3072
    v_mfma_f32_32x32x16_bf16 v[32:47], v[148:151], v[88:91], v[32:47]
    ds_read_b64_tr_b16 v[140:141], v9 offset:2048
    ds_read_b64_tr_b16 v[142:143], v9 offset:3072
    s_add_u32 m0, s62, 139264
    s_add_u32 s98, s55, 1638400
    buffer_load_dwordx4 v6, s[28:31], s98 offen lds
    s_waitcnt lgkmcnt(8)
    v_mfma_f32_32x32x16_bf16 v[16:31], v[152:155], v[92:95], v[16:31]
    ds_read_b64_tr_b16 v[144:145], v8 offset:4096
    ds_read_b64_tr_b16 v[146:147], v8 offset:5120
    v_mfma_f32_32x32x16_bf16 v[32:47], v[156:159], v[92:95], v[32:47]
    ds_read_b64_tr_b16 v[148:149], v9 offset:4096
    ds_read_b64_tr_b16 v[150:151], v9 offset:5120
    s_add_u32 m0, s62, 147456
    s_add_u32 s98, s55, 1703936
    buffer_load_dwordx4 v6, s[28:31], s98 offen lds
    s_waitcnt lgkmcnt(8)
    v_mfma_f32_32x32x16_bf16 v[16:31], v[128:131], v[96:99], v[16:31]
    ds_read_b64_tr_b16 v[152:153], v8 offset:6144
    ds_read_b64_tr_b16 v[154:155], v8 offset:7168
    v_mfma_f32_32x32x16_bf16 v[32:47], v[132:135], v[96:99], v[32:47]
    ds_read_b64_tr_b16 v[156:157], v9 offset:6144
    ds_read_b64_tr_b16 v[158:159], v9 offset:7168
    s_add_u32 m0, s62, 155648
    s_add_u32 s98, s55, 1769472
    buffer_load_dwordx4 v6, s[28:31], s98 offen lds
    s_waitcnt lgkmcnt(8)
    v_mfma_f32_32x32x16_bf16 v[16:31], v[136:139], v[100:103], v[16:31]
    v_mfma_f32_32x32x16_bf16 v[32:47], v[140:143], v[100:103], v[32:47]
    s_waitcnt lgkmcnt(0)
    s_barrier
    v_add_u32 v8, 98304, v5
    v_xor_b32 v9, 64, v8
    ds_read_b64_tr_b16 v[128:129], v8 offset:0
    ds_read_b64_tr_b16 v[130:131], v8 offset:1024
    ds_read_b64_tr_b16 v[132:133], v9 offset:0
    ds_read_b64_tr_b16 v[134:135], v9 offset:1024
    s_add_u32 m0, s62, 0
    s_add_u32 s98, s55, 0
    buffer_load_dwordx4 v6, s[16:19], s98 offen lds
    v_mfma_f32_32x32x16_bf16 v[16:31], v[144:147], v[104:107], v[16:31]
    ds_read_b64_tr_b16 v[136:137], v8 offset:2048
    ds_read_b64_tr_b16 v[138:139], v8 offset:3072
    v_mfma_f32_32x32x16_bf16 v[32:47], v[148:151], v[104:107], v[32:47]
    ds_read_b64_tr_b16 v[140:141], v9 offset:2048
    ds_read_b64_tr_b16 v[142:143], v9 offset:3072
    s_add_u32 m0, s62, 8192
    s_add_u32 s98, s55, 65536
    buffer_load_dwordx4 v6, s[16:19], s98 offen lds
    v_mfma_f32_32x32x16_bf16 v[16:31], v[152:155], v[108:111], v[16:31]
    ds_read_b64_tr_b16 v[144:145], v8 offset:4096
    ds_read_b64_tr_b16 v[146:147], v8 offset:5120
    v_mfma_f32_32x32x16_bf16 v[32:47], v[156:159], v[108:111], v[32:47]
    ds_read_b64_tr_b16 v[148:149], v9 offset:4096
    ds_read_b64_tr_b16 v[150:151], v9 offset:5120
    s_add_u32 m0, s62, 16384
    s_add_u32 s98, s55, 131072
    buffer_load_dwordx4 v6, s[16:19], s98 offen lds
    s_waitcnt lgkmcnt(8)
    v_mfma_f32_32x32x16_bf16 v[16:31], v[128:131], v[112:115], v[16:31]
    ds_read_b64_tr_b16 v[152:153], v8 offset:6144
    ds_read_b64_tr_b16 v[154:155], v8 offset:7168
    v_mfma_f32_32x32x16_bf16 v[32:47], v[132:135], v[112:115], v[32:47]
    ds_read_b64_tr_b16 v[156:157], v9 offset:6144
    ds_read_b64_tr_b16 v[158:159], v9 offset:7168
    s_add_u32 m0, s62, 24576
    s_add_u32 s98, s55, 196608
    buffer_load_dwordx4 v6, s[16:19], s98 offen lds
    s_waitcnt lgkmcnt(8)
    v_mfma_f32_32x32x16_bf16 v[16:31], v[136:139], v[116:119], v[16:31]
    v_mfma_f32_32x32x16_bf16 v[32:47], v[140:143], v[116:119], v[32:47]
    s_waitcnt vmcnt(4) lgkmcnt(0)
    s_barrier
    v_add_u32 v8, 65536, v5
    v_xor_b32 v9, 64, v8
    ds_read_b64_tr_b16 v[128:129], v8 offset:0
    ds_read_b64_tr_b16 v[130:131], v8 offset:1024
    ds_read_b64_tr_b16 v[132:133], v9 offset:0
    ds_read_b64_tr_b16 v[134:135], v9 offset:1024
    s_add_u32 m0, s62, 32768
    s_add_u32 s98, s55, 262144
    buffer_load_dwordx4 v6, s[16:19], s98 offen lds
    v_and_b32 v124, 3, v2
    v_bfe_u32 v12, v2, 2, 1
    v_lshlrev_b32 v124, 10, v124
    v_lshl_add_u32 v124, v12, 14, v124
    s_mov_b64 exec, 0xff
    buffer_load_dword v125, v124, s[40:43], s66 offen offset:1020 sc1
    s_mov_b64 exec, -1
    v_mfma_f32_32x32x16_bf16 v[16:31], v[144:147], v[216:219], v[16:31]
    ds_read_b64_tr_b16 v[136:137], v8 offset:2048
    ds_read_b64_tr_b16 v[138:139], v8 offset:3072
    v_mfma_f32_32x32x16_bf16 v[32:47], v[148:151], v[216:219], v[32:47]
    ds_read_b64_tr_b16 v[140:141], v9 offset:2048
    ds_read_b64_tr_b16 v[142:143], v9 offset:3072
    s_add_u32 m0, s62, 40960
    s_add_u32 s98, s55, 327680
    buffer_load_dwordx4 v6, s[16:19], s98 offen lds
    v_mfma_f32_32x32x16_bf16 v[16:31], v[152:155], v[220:223], v[16:31]
    ds_read_b64_tr_b16 v[144:145], v8 offset:4096
    ds_read_b64_tr_b16 v[146:147], v8 offset:5120
    v_mfma_f32_32x32x16_bf16 v[32:47], v[156:159], v[220:223], v[32:47]
    ds_read_b64_tr_b16 v[148:149], v9 offset:4096
    ds_read_b64_tr_b16 v[150:151], v9 offset:5120
    s_add_u32 m0, s62, 49152
    s_add_u32 s98, s55, 393216
    buffer_load_dwordx4 v6, s[16:19], s98 offen lds
    s_waitcnt vmcnt(2)
    v_cmp_eq_u32 vcc, -1, v125
    s_nop 0
    s_and_b32 vcc_lo, vcc_lo, 0xff
    s_cbranch_scc1 L_op
L_op_r:
    s_waitcnt lgkmcnt(8)
    v_mfma_f32_32x32x16_bf16 v[16:31], v[128:131], v[224:227], v[16:31]
    ds_read_b64_tr_b16 v[152:153], v8 offset:6144
    ds_read_b64_tr_b16 v[154:155], v8 offset:7168
    v_mfma_f32_32x32x16_bf16 v[32:47], v[132:135], v[224:227], v[32:47]
    ds_read_b64_tr_b16 v[156:157], v9 offset:6144
    ds_read_b64_tr_b16 v[158:159], v9 offset:7168
    s_add_u32 m0, s62, 57344
    s_add_u32 s98, s55, 458752
    buffer_load_dwordx4 v6, s[16:19], s98 offen lds
    buffer_load_dwordx4 v[160:163], v3, s[40:43], s66 offen offset:0 sc1
    buffer_load_dwordx4 v[164:167], v3, s[40:43], s66 offen offset:1024 sc1
    s_and_b32 s99, s44, 1
    s_lshl_b32 s99, s99, 15
    s_add_u32 s99, s99, 65536
    s_lshl_b32 s100, s101, 13
    s_add_u32 s100, s100, s99
    v_lshrrev_b32 v14, 5, v2
    v_and_b32 v13, 15, v2
    v_xor_b32 v14, v14, v13
    v_and_b32 v13, 31, v2
    v_lshlrev_b32 v13, 8, v13
    v_lshl_add_u32 v13, v14, 4, v13
    v_add_u32 v48, s100, v13
    v_xor_b32 v49, 32, v48
    v_xor_b32 v50, 64, v48
    v_xor_b32 v51, 96, v48
    v_xor_b32 v52, 128, v48
    v_xor_b32 v53, 160, v48
    v_xor_b32 v54, 192, v48
    v_xor_b32 v55, 224, v48
    s_waitcnt lgkmcnt(8)
    v_mfma_f32_32x32x16_bf16 v[16:31], v[136:139], v[228:231], v[16:31]
    v_add_u32 v8, 131072, v5
    v_xor_b32 v9, 64, v8
    ds_read_b64_tr_b16 v[128:129], v8 offset:0
    ds_read_b64_tr_b16 v[130:131], v8 offset:1024
    v_mfma_f32_32x32x16_bf16 v[32:47], v[140:143], v[228:231], v[32:47]
    ds_read_b64_tr_b16 v[132:133], v9 offset:0
    ds_read_b64_tr_b16 v[134:135], v9 offset:1024
    buffer_load_dwordx4 v[168:171], v3, s[40:43], s66 offen offset:2048 sc1
    buffer_load_dwordx4 v[172:175], v3, s[40:43], s66 offen offset:3072 sc1
    s_waitcnt lgkmcnt(8)
    v_mfma_f32_32x32x16_bf16 v[16:31], v[144:147], v[232:235], v[16:31]
    ds_read_b64_tr_b16 v[136:137], v8 offset:2048
    ds_read_b64_tr_b16 v[138:139], v8 offset:3072
    v_mfma_f32_32x32x16_bf16 v[32:47], v[148:151], v[232:235], v[32:47]
    ds_read_b64_tr_b16 v[140:141], v9 offset:2048
    ds_read_b64_tr_b16 v[142:143], v9 offset:3072
    buffer_load_dwordx4 v[176:179], v3, s[40:43], s65 offen offset:0 sc1
    v_lshrrev_b32 v14, 3, v2
    s_lshl_b32 s100, s101, 3
    v_add_u32 v14, s100, v14
    v_and_b32 v13, 7, v2
    v_lshlrev_b32 v1, 1, v13
    v_and_b32 v127, 15, v14
    v_xor_b32 v127, v127, v1
    v_lshlrev_b32 v127, 4, v127
    v_lshl_add_u32 v127, v14, 8, v127
    s_and_b32 s99, s44, 1
    s_lshl_b32 s99, s99, 15
    s_add_u32 s99, s99, 65536
    v_add_u32 v127, s99, v127
    v_xor_b32 v1, 16, v127
    v_lshlrev_b32 v13, 4, v13
    v_lshl_add_u32 v13, v14, 10, v13
    s_lshl_b32 s99, s69, 15
    s_lshr_b32 s100, s48, 1
    s_lshl_b32 s100, s100, 7
    s_add_u32 s57, s99, s100
    s_waitcnt lgkmcnt(8)
    v_mfma_f32_32x32x16_bf16 v[16:31], v[152:155], v[236:239], v[16:31]
    ds_read_b64_tr_b16 v[144:145], v8 offset:4096
    ds_read_b64_tr_b16 v[146:147], v8 offset:5120
    v_mfma_f32_32x32x16_bf16 v[32:47], v[156:159], v[236:239], v[32:47]
    ds_read_b64_tr_b16 v[148:149], v9 offset:4096
    ds_read_b64_tr_b16 v[150:151], v9 offset:5120
    buffer_load_dwordx4 v[180:183], v3, s[40:43], s65 offen offset:1024 sc1
    buffer_load_dwordx4 v[184:187], v3, s[40:43], s65 offen offset:2048 sc1
    s_waitcnt lgkmcnt(8)
    v_mfma_f32_32x32x16_bf16 v[16:31], v[128:131], v[240:243], v[16:31]
    ds_read_b64_tr_b16 v[152:153], v8 offset:6144
    ds_read_b64_tr_b16 v[154:155], v8 offset:7168
    v_mfma_f32_32x32x16_bf16 v[32:47], v[132:135], v[240:243], v[32:47]
    ds_read_b64_tr_b16 v[156:157], v9 offset:6144
    ds_read_b64_tr_b16 v[158:159], v9 offset:7168
    buffer_load_dwordx4 v[188:191], v3, s[40:43], s65 offen offset:3072 sc1
    s_waitcnt lgkmcnt(8)
    v_mfma_f32_32x32x16_bf16 v[16:31], v[136:139], v[244:247], v[16:31]
    v_mfma_f32_32x32x16_bf16 v[32:47], v[140:143], v[244:247], v[32:47]
    s_waitcnt vmcnt(8) lgkmcnt(0)
    s_barrier
    v_add_u32 v8, 0, v5
    v_xor_b32 v9, 64, v8
    ds_read_b64_tr_b16 v[128:129], v8 offset:0
    ds_read_b64_tr_b16 v[130:131], v8 offset:1024
    ds_read_b64_tr_b16 v[132:133], v9 offset:0
    ds_read_b64_tr_b16 v[134:135], v9 offset:1024
    v_mfma_f32_32x32x16_bf16 v[16:31], v[144:147], v[248:251], v[16:31]
    v_mfma_f32_32x32x16_bf16 v[16:31], v[152:155], v[252:255], v[16:31]
    v_mfma_f32_32x32x16_bf16 v[32:47], v[148:151], v[248:251], v[32:47]
    ds_read_b64_tr_b16 v[136:137], v8 offset:2048
    ds_read_b64_tr_b16 v[138:139], v8 offset:3072
    ds_read_b64_tr_b16 v[140:141], v9 offset:2048
    ds_read_b64_tr_b16 v[142:143], v9 offset:3072
    v_mfma_f32_32x32x16_bf16 v[32:47], v[156:159], v[252:255], v[32:47]
    ds_read_b64_tr_b16 v[144:145], v8 offset:4096
    ds_read_b64_tr_b16 v[146:147], v8 offset:5120
    ds_read_b64_tr_b16 v[148:149], v9 offset:4096
    ds_read_b64_tr_b16 v[150:151], v9 offset:5120
    s_nop 1
    v_mul_f32 v16, v16, v126
    v_mul_f32 v17, v17, v126
    v_mul_f32 v18, v18, v126
    v_mul_f32 v19, v19, v126
    v_mul_f32 v20, v20, v126
    v_mul_f32 v21, v21, v126
    v_mul_f32 v22, v22, v126
    v_mul_f32 v23, v23, v126
    v_mul_f32 v24, v24, v126
    v_mul_f32 v25, v25, v126
    v_mul_f32 v26, v26, v126
    v_mul_f32 v27, v27, v126
    v_mul_f32 v28, v28, v126
    v_mul_f32 v29, v29, v126
    v_mul_f32 v30, v30, v126
    v_mul_f32 v31, v31, v126
    s_waitcnt vmcnt(7) lgkmcnt(8)
    v_max3_u32 v11, v160, v161, v162
    v_max_u32 v11, v11, v163
    v_cmp_eq_u32 vcc, -1, v11
    s_nop 0
    s_cbranch_vccnz L_or0
L_or0_r:
    v_mfma_f32_32x32x16_bf16 v[16:31], v[128:131], v[160:163], v[16:31]
    v_mul_f32 v32, v32, v126
    v_mul_f32 v33, v33, v126
    v_mul_f32 v34, v34, v126
    v_mul_f32 v35, v35, v126
    v_mul_f32 v36, v36, v126
    v_mul_f32 v37, v37, v126
    v_mul_f32 v38, v38, v126
    v_mul_f32 v39, v39, v126
    v_mul_f32 v40, v40, v126
    v_mul_f32 v41, v41, v126
    v_mul_f32 v42, v42, v126
    v_mul_f32 v43, v43, v126
    v_mul_f32 v44, v44, v126
    v_mul_f32 v45, v45, v126
    v_mul_f32 v46, v46, v126
    v_mul_f32 v47, v47, v126
    s_waitcnt vmcnt(6) lgkmcnt(4)
    v_max3_u32 v11, v164, v165, v166
    v_max_u32 v11, v11, v167
    v_cmp_eq_u32 vcc, -1, v11
    s_nop 0
    s_cbranch_vccnz L_or1
L_or1_r:
    v_mfma_f32_32x32x16_bf16 v[16:31], v[136:139], v[164:167], v[16:31]
    v_mfma_f32_32x32x16_bf16 v[32:47], v[132:135], v[160:163], v[32:47]
    ds_read_b64_tr_b16 v[152:153], v8 offset:6144
    ds_read_b64_tr_b16 v[154:155], v8 offset:7168
    ds_read_b64_tr_b16 v[156:157], v9 offset:6144
    ds_read_b64_tr_b16 v[158:159], v9 offset:7168
    v_mfma_f32_32x32x16_bf16 v[32:47], v[140:143], v[164:167], v[32:47]
    v_add_u32 v8, 32768, v5
    v_xor_b32 v9, 64, v8
    ds_read_b64_tr_b16 v[128:129], v8 offset:0
    ds_read_b64_tr_b16 v[130:131], v8 offset:1024
    ds_read_b64_tr_b16 v[132:133], v9 offset:0
    ds_read_b64_tr_b16 v[134:135], v9 offset:1024
    s_waitcnt vmcnt(5) lgkmcnt(8)
    v_max3_u32 v11, v168, v169, v170
    v_max_u32 v11, v11, v171
    v_cmp_eq_u32 vcc, -1, v11
    s_nop 0
    s_cbranch_vccnz L_or2
L_or2_r:
    v_mfma_f32_32x32x16_bf16 v[16:31], v[144:147], v[168:171], v[16:31]
    ds_read_b64_tr_b16 v[136:137], v8 offset:2048
    ds_read_b64_tr_b16 v[138:139], v8 offset:3072
    v_mfma_f32_32x32x16_bf16 v[32:47], v[148:151], v[168:171], v[32:47]
    ds_read_b64_tr_b16 v[140:141], v9 offset:2048
    ds_read_b64_tr_b16 v[142:143], v9 offset:3072
    s_waitcnt vmcnt(4) lgkmcnt(8)
    v_max3_u32 v11, v172, v173, v174
    v_max_u32 v11, v11, v175
    v_cmp_eq_u32 vcc, -1, v11
    s_nop 0
    s_cbranch_vccnz L_or3
L_or3_r:
    v_mfma_f32_32x32x16_bf16 v[16:31], v[152:155], v[172:175], v[16:31]
    ds_read_b64_tr_b16 v[144:145], v8 offset:4096
    ds_read_b64_tr_b16 v[146:147], v8 offset:5120
    v_mfma_f32_32x32x16_bf16 v[32:47], v[156:159], v[172:175], v[32:47]
    ds_read_b64_tr_b16 v[148:149], v9 offset:4096
    ds_read_b64_tr_b16 v[150:151], v9 offset:5120
    s_waitcnt vmcnt(3) lgkmcnt(8)
    ds_read_b64_tr_b16 v[152:153], v8 offset:6144
    ds_read_b64_tr_b16 v[154:155], v8 offset:7168
    ds_read_b64_tr_b16 v[156:157], v9 offset:6144
    ds_read_b64_tr_b16 v[158:159], v9 offset:7168
    v_max3_u32 v11, v176, v177, v178
    v_max_u32 v11, v11, v179
    v_cmp_eq_u32 vcc, -1, v11
    s_nop 0
    s_cbranch_vccnz L_or4
L_or4_r:
    v_mfma_f32_32x32x16_bf16 v[16:31], v[128:131], v[176:179], v[16:31]
    s_waitcnt vmcnt(2) lgkmcnt(8)
    v_max3_u32 v11, v180, v181, v182
    v_max_u32 v11, v11, v183
    v_cmp_eq_u32 vcc, -1, v11
    s_nop 0
    s_cbranch_vccnz L_or5
L_or5_r:
    v_mfma_f32_32x32x16_bf16 v[16:31], v[136:139], v[180:183], v[16:31]
    s_waitcnt vmcnt(1) lgkmcnt(4)
    v_max3_u32 v11, v184, v185, v186
    v_max_u32 v11, v11, v187
    v_cmp_eq_u32 vcc, -1, v11
    s_nop 0
    s_cbranch_vccnz L_or6
L_or6_r:
    v_mfma_f32_32x32x16_bf16 v[16:31], v[144:147], v[184:187], v[16:31]
    s_waitcnt vmcnt(0) lgkmcnt(0)
    v_max3_u32 v11, v188, v189, v190
    v_max_u32 v11, v11, v191
    v_cmp_eq_u32 vcc, -1, v11
    s_nop 0
    s_cbranch_vccnz L_or7
L_or7_r:
    v_mfma_f32_32x32x16_bf16 v[16:31], v[152:155], v[188:191], v[16:31]
    v_mfma_f32_32x32x16_bf16 v[32:47], v[132:135], v[176:179], v[32:47]
    v_mfma_f32_32x32x16_bf16 v[32:47], v[140:143], v[180:183], v[32:47]
    v_mfma_f32_32x32x16_bf16 v[32:47], v[148:151], v[184:187], v[32:47]
    s_nop 8
    ds_write_b128 v48, v[16:19]
    ds_write_b128 v49, v[20:23]
    v_mfma_f32_32x32x16_bf16 v[32:47], v[156:159], v[188:191], v[32:47]
    ds_write_b128 v50, v[24:27]
    ds_write_b128 v51, v[28:31]
    s_nop 9
    ds_write_b128 v52, v[32:35]
    ds_write_b128 v53, v[36:39]
    ds_write_b128 v54, v[40:43]
    ds_write_b128 v55, v[44:47]
    s_waitcnt lgkmcnt(0)
    s_barrier
    ds_read_b128 v[64:67], v127 offset:0
    ds_read_b128 v[68:71], v1 offset:0
    ds_read_b128 v[72:75], v127 offset:8192
    ds_read_b128 v[76:79], v1 offset:8192
    ds_read_b128 v[80:83], v127 offset:16384
    ds_read_b128 v[84:87], v1 offset:16384
    ds_read_b128 v[88:91], v127 offset:24576
    ds_read_b128 v[92:95], v1 offset:24576
    s_waitcnt lgkmcnt(4)
    v_pk_add_f32 v[64:65], v[64:65], v[72:73]
    v_pk_add_f32 v[66:67], v[66:67], v[74:75]
    v_pk_add_f32 v[68:69], v[68:69], v[76:77]
    v_pk_add_f32 v[70:71], v[70:71], v[78:79]
    s_waitcnt lgkmcnt(0)
    v_pk_add_f32 v[80:81], v[80:81], v[88:89]
    v_pk_add_f32 v[82:83], v[82:83], v[90:91]
    v_pk_add_f32 v[84:85], v[84:85], v[92:93]
    v_pk_add_f32 v[86:87], v[86:87], v[94:95]
    v_pk_add_f32 v[64:65], v[64:65], v[80:81]
    v_pk_add_f32 v[66:67], v[66:67], v[82:83]
    v_pk_add_f32 v[68:69], v[68:69], v[84:85]
    v_pk_add_f32 v[70:71], v[70:71], v[86:87]
    v_cvt_pk_bf16_f32 v72, v64, v65
    v_cvt_pk_bf16_f32 v73, v66, v67
    v_cvt_pk_bf16_f32 v74, v68, v69
    v_cvt_pk_bf16_f32 v75, v70, v71
    buffer_store_dwordx4 v[72:75], v13, s[36:39], s57 offen sc0 sc1
L_end:
    s_endpgm
L_quick:
    v_and_b32 v13, 15, v2
    v_lshrrev_b32 v14, 4, v2
    s_mul_i32 s101, s44, 9344
    s_add_u32 s101, s101, 115264
    v_and_b32 v11, 3, v2
    v_mul_u32_u24 v11, 1040, v11
    v_bfe_u32 v12, v2, 2, 2
    v_lshl_add_u32 v11, v12, 8, v11
    v_lshl_add_u32 v11, v14, 4, v11
    v_add_u32 v11, s101, v11
    v_lshlrev_b32 v12, 8, v14
    v_lshl_add_u32 v12, v13, 3, v12
    v_add_u32 v12, s101, v12
    v_lshl_add_u32 v58, v14, 4, s101
    v_add_u32 v59, s101, v3
    s_and_b32 s99, s48, 1
    s_waitcnt vmcnt(0)
    ds_read_b128 v[240:243], v11 offset:0
    ds_read_b64_tr_b16 v[60:61], v12 offset:4160
    ds_read_b64_tr_b16 v[62:63], v12 offset:4288
    ds_read_b128 v[244:247], v11 offset:64
    ds_read_b64_tr_b16 v[64:65], v12 offset:5184
    ds_read_b64_tr_b16 v[66:67], v12 offset:5312
    ds_read_b128 v[248:251], v11 offset:128
    ds_read_b64_tr_b16 v[68:69], v12 offset:6208
    ds_read_b64_tr_b16 v[70:71], v12 offset:6336
    ds_read_b128 v[252:255], v11 offset:192
    ds_read_b64_tr_b16 v[72:73], v12 offset:7232
    ds_read_b64_tr_b16 v[74:75], v12 offset:7360
    s_cmp_eq_u32 s99, 1
    s_cbranch_scc1 L_quick_V
    s_waitcnt lgkmcnt(9)
    ds_read_b128 v[224:227], v58 offset:8256
    ds_read_b128 v[228:231], v58 offset:8320
    ds_read_b128 v[232:235], v58 offset:8384
    ds_read_b128 v[236:239], v58 offset:8448
    v_mfma_f32_16x16x32_bf16 v[48:51], v[60:63], v[240:243], 0
    s_waitcnt lgkmcnt(10)
    v_mfma_f32_16x16x32_bf16 v[48:51], v[64:67], v[244:247], v[48:51]
    s_waitcnt lgkmcnt(7)
    v_mfma_f32_16x16x32_bf16 v[48:51], v[68:71], v[248:251], v[48:51]
    s_waitcnt lgkmcnt(4)
    v_mfma_f32_16x16x32_bf16 v[48:51], v[72:75], v[252:255], v[48:51]
    s_waitcnt lgkmcnt(3)
    v_mfma_f32_16x16x32_bf16 v[52:55], v[224:227], v[240:243], 0
    s_waitcnt lgkmcnt(2)
    v_mfma_f32_16x16x32_bf16 v[52:55], v[228:231], v[244:247], v[52:55]
    s_waitcnt lgkmcnt(1)
    v_mfma_f32_16x16x32_bf16 v[52:55], v[232:235], v[248:251], v[52:55]
    s_waitcnt lgkmcnt(0)
    v_mfma_f32_16x16x32_bf16 v[52:55], v[236:239], v[252:255], v[52:55]
    s_nop 0
    ds_write_b128 v59, v[48:51]
    s_nop 5
    ds_write_b128 v59, v[52:55] offset:1024
    s_branch L_quick_done
L_quick_V:
    s_waitcnt lgkmcnt(9)
    v_mfma_f32_16x16x32_bf16 v[48:51], v[240:243], v[60:63], 0
    s_waitcnt lgkmcnt(6)
    v_mfma_f32_16x16x32_bf16 v[48:51], v[244:247], v[64:67], v[48:51]
    s_waitcnt lgkmcnt(3)
    v_mfma_f32_16x16x32_bf16 v[48:51], v[248:251], v[68:71], v[48:51]
    s_waitcnt lgkmcnt(0)
    v_mfma_f32_16x16x32_bf16 v[48:51], v[252:255], v[72:75], v[48:51]
    s_nop 7
    ds_write_b128 v59, v[48:51]
    s_branch L_quick_done
L_qfin:
    s_cmp_eq_u32 s44, 1
    s_cbranch_scc1 L_qf1
    s_cmp_eq_u32 s44, 2
    s_cbranch_scc1 L_qf2
    v_add_u32 v70, 115264, v3
    ds_read_b128 v[48:51], v70 offset:0
    ds_read_b128 v[52:55], v70 offset:9344
    ds_read_b128 v[56:59], v70 offset:18688
    ds_read_b128 v[60:63], v70 offset:28032
    v_and_b32 v13, 15, v2
    v_lshrrev_b32 v14, 4, v2
    s_lshr_b32 s100, s48, 2
    s_lshl_b32 s101, s47, 2
    s_add_u32 s100, s100, s101
    s_lshl_b32 s100, s100, 11
    s_lshr_b32 s101, s48, 1
    s_and_b32 s101, s101, 1
    s_lshl_b32 s101, s101, 8
    s_add_u32 s100, s100, s101
    v_and_b32 v11, 1, v14
    v_lshrrev_b32 v12, 1, v14
    s_and_b32 s99, s48, 1
    s_lshl_b32 s101, s99, 10
    s_add_u32 s100, s100, s101
    s_cmp_eq_u32 s99, 1
    s_cselect_b64 vcc, -1, 0
    v_cndmask_b32 v68, v11, v12, vcc
    v_cndmask_b32 v69, v12, v11, vcc
    v_lshlrev_b32 v11, 9, v68
    v_lshl_add_u32 v11, v13, 4, v11
    v_lshl_add_u32 v11, v69, 3, v11
    s_waitcnt lgkmcnt(0)
    v_add_f32 v48, v48, v52
    v_add_f32 v56, v56, v60
    v_add_f32 v49, v49, v53
    v_add_f32 v57, v57, v61
    v_add_f32 v50, v50, v54
    v_add_f32 v58, v58, v62
    v_add_f32 v51, v51, v55
    v_add_f32 v59, v59, v63
    v_add_f32 v48, v48, v56
    v_add_f32 v49, v49, v57
    v_add_f32 v50, v50, v58
    v_add_f32 v51, v51, v59
    v_cvt_pk_bf16_f32 v52, v48, v49
    v_cvt_pk_bf16_f32 v53, v50, v51
    buffer_store_dwordx2 v[52:53], v11, s[40:43], s100 offen sc1
    s_branch L_qfin_r
L_qf1:
    v_add_u32 v70, 115264, v3
    ds_read_b32 v64, v70 offset:1024
    ds_read_b32 v65, v70 offset:10368
    ds_read_b32 v66, v70 offset:19712
    ds_read_b32 v67, v70 offset:29056
    s_lshl_b32 s100, s47, 9
    s_lshr_b32 s101, s48, 1
    s_lshl_b32 s101, s101, 6
    s_add_u32 s100, s100, s101
    s_add_u32 s100, s100, 131072
    s_bitcmp1_b32 s48, 0
    s_cselect_b32 s100, 0x40000000, s100
    v_and_b32 v11, 15, v2
    v_lshlrev_b32 v11, 2, v11
    s_waitcnt lgkmcnt(0)
    v_add_f32 v64, v64, v65
    v_add_f32 v66, v66, v67
    v_add_f32 v64, v64, v66
    buffer_store_dword v64, v11, s[40:43], s100 offen sc1
    s_branch L_qfin_r
L_qf2:
    v_add_u32 v70, 115264, v3
    ds_read_b128 v[48:51], v70 offset:0
    ds_read_b128 v[52:55], v70 offset:9344
    ds_read_b128 v[56:59], v70 offset:18688
    ds_read_b128 v[60:63], v70 offset:28032
    s_waitcnt lgkmcnt(0)
    v_add_f32 v48, v48, v52
    v_add_f32 v56, v56, v60
    v_add_f32 v49, v49, v53
    v_add_f32 v57, v57, v61
    v_add_f32 v50, v50, v54
    v_add_f32 v58, v58, v62
    v_add_f32 v51, v51, v55
    v_add_f32 v59, v59, v63
    v_add_f32 v48, v48, v56
    v_add_f32 v49, v49, v57
    v_add_f32 v50, v50, v58
    v_add_f32 v51, v51, v59
    v_mul_f32 v54, v48, v48
    v_fmac_f32 v54, v49, v49
    v_fmac_f32 v54, v50, v50
    v_fmac_f32 v54, v51, v51
    v_mov_b32 v55, v54
    s_nop 1
    v_permlane16_swap_b32 v54, v55
    s_nop 0
    v_add_f32 v54, v54, v55
    v_mov_b32 v55, v54
    s_nop 1
    v_permlane32_swap_b32 v54, v55
    s_nop 0
    v_add_f32 v54, v54, v55
    s_nop 1
    v_max_f32_dpp v54, v54, v54 row_ror:8 row_mask:0xf bank_mask:0xf
    s_nop 1
    v_max_f32_dpp v54, v54, v54 row_ror:4 row_mask:0xf bank_mask:0xf
    s_nop 1
    v_max_f32_dpp v54, v54, v54 row_ror:2 row_mask:0xf bank_mask:0xf
    s_nop 1
    v_max_f32_dpp v54, v54, v54 row_ror:1 row_mask:0xf bank_mask:0xf
    s_bitcmp1_b32 s48, 0
    s_cselect_b64 vcc, -1, 0
    v_cndmask_b32 v253, v54, 0, vcc
    s_branch L_qfin_r
L_kvf:
    v_mov_b32 v252, s49
    s_lshl_b32 s99, s67, 4
    s_add_u32 s99, s99, 147456
    v_mov_b32 v11, 0
    s_mov_b64 exec, 1
    buffer_store_dwordx2 v[252:253], v11, s[40:43], s99 offen sc1
    s_mov_b64 exec, -1
    s_branch L_kvf_r
L_kvi:
    s_mov_b32 s99, 147456
    buffer_load_dwordx2 v[240:241], v3, s[40:43], s99 offen offset:0 sc1
    buffer_load_dwordx2 v[242:243], v3, s[40:43], s99 offen offset:1024 sc1
    buffer_load_dwordx2 v[244:245], v3, s[40:43], s99 offen offset:2048 sc1
    buffer_load_dwordx2 v[246:247], v3, s[40:43], s99 offen offset:3072 sc1
    s_branch L_kvi_r
L_kvc:
    s_waitcnt vmcnt(7)
L_kvp_chk:
    v_cmp_ne_u32 vcc, s49, v240
    v_cmp_ne_u32 s[100:101], s49, v242
    s_nop 0
    s_or_b64 vcc, vcc, s[100:101]
    v_cmp_ne_u32 s[100:101], s49, v244
    s_nop 0
    s_or_b64 vcc, vcc, s[100:101]
    v_cmp_ne_u32 s[100:101], s49, v246
    s_nop 0
    s_or_b64 vcc, vcc, s[100:101]
    s_cbranch_vccz L_kvp_ok
    s_add_u32 s3, s3, 1
    s_cmp_gt_u32 s3, 200000
    s_cbranch_scc1 L_kvp_ok
    s_sleep 16
    s_mov_b32 s99, 147456
    buffer_load_dwordx2 v[240:241], v3, s[40:43], s99 offen offset:0 sc1
    buffer_load_dwordx2 v[242:243], v3, s[40:43], s99 offen offset:1024 sc1
    buffer_load_dwordx2 v[244:245], v3, s[40:43], s99 offen offset:2048 sc1
    buffer_load_dwordx2 v[246:247], v3, s[40:43], s99 offen offset:3072 sc1
    s_waitcnt vmcnt(0)
    s_branch L_kvp_chk
L_kvp_ok:
    v_max_f32 v241, v241, v243
    v_max3_f32 v248, v241, v245, v247
    v_lshlrev_b32 v13, 7, v2
    s_lshr_b32 s99, s2, 3
    s_lshl_b32 s99, s99, 12
    s_mov_b64 exec, 0xffffffff
    buffer_load_dword v195, v13, s[40:43], s99 offen sc1
    s_mov_b64 exec, -1
    s_branch L_kvc_r
L_kvn:
    v_mov_b32 v249, v248
    s_nop 1
    v_permlane16_swap_b32 v248, v249
    s_nop 0
    v_max_f32 v248, v248, v249
    v_mov_b32 v249, v248
    s_nop 1
    v_permlane32_swap_b32 v248, v249
    s_nop 0
    v_max_f32 v248, v248, v249
    s_nop 1
    v_max_f32_dpp v248, v248, v248 row_ror:8 row_mask:0xf bank_mask:0xf
    s_nop 1
    v_max_f32_dpp v248, v248, v248 row_ror:4 row_mask:0xf bank_mask:0xf
    s_nop 1
    v_max_f32_dpp v248, v248, v248 row_ror:2 row_mask:0xf bank_mask:0xf
    s_nop 1
    v_max_f32_dpp v248, v248, v248 row_ror:1 row_mask:0xf bank_mask:0xf
    v_mov_b32 v249, 120000
    ds_write_b32 v249, v248
    s_cmp_lg_u32 s2, 0
    s_cbranch_scc1 L_kvp_end
    v_mov_b32 v249, s49
    v_mov_b32 v248, 139264
    s_mov_b64 exec, 1
    buffer_store_dword v249, v248, s[40:43], 0 offen sc1
    s_mov_b64 exec, -1
L_kvp_end:
    s_branch L_kvn_r
L_hp_f:
    s_add_u32 s3, s3, 1
    s_cmp_gt_u32 s3, 200000
    s_cbranch_scc1 L_hp_f_r
    s_sleep 16
    buffer_load_dword v12, v13, s[40:43], s66 offen sc1
    s_waitcnt vmcnt(0)
    v_cmp_ne_u32 vcc, s49, v12
    s_nop 0
    s_cbranch_vccnz L_hp_f
    s_branch L_hp_f_r
L_op:
    s_add_u32 s3, s3, 1
    s_cmp_gt_u32 s3, 200000
    s_cbranch_scc1 L_op_r
    s_sleep 8
    s_mov_b64 exec, 0xff
    buffer_load_dword v125, v124, s[40:43], s66 offen offset:1020 sc1
    s_mov_b64 exec, -1
    s_waitcnt vmcnt(0)
    v_cmp_eq_u32 vcc, -1, v125
    s_nop 0
    s_and_b32 vcc_lo, vcc_lo, 0xff
    s_cbranch_scc1 L_op
    s_branch L_op_r
L_or0:
    s_add_u32 s3, s3, 1
    s_cmp_gt_u32 s3, 200000
    s_cbranch_scc1 L_or0_r
    s_sleep 2
    buffer_load_dwordx4 v[160:163], v3, s[40:43], s66 offen offset:0 sc1
    s_waitcnt vmcnt(0)
    v_max3_u32 v11, v160, v161, v162
    v_max_u32 v11, v11, v163
    v_cmp_eq_u32 vcc, -1, v11
    s_nop 0
    s_cbranch_vccnz L_or0
    s_branch L_or0_r
L_or1:
    s_add_u32 s3, s3, 1
    s_cmp_gt_u32 s3, 200000
    s_cbranch_scc1 L_or1_r
    s_sleep 2
    buffer_load_dwordx4 v[164:167], v3, s[40:43], s66 offen offset:1024 sc1
    s_waitcnt vmcnt(0)
    v_max3_u32 v11, v164, v165, v166
    v_max_u32 v11, v11, v167
    v_cmp_eq_u32 vcc, -1, v11
    s_nop 0
    s_cbranch_vccnz L_or1
    s_branch L_or1_r
L_or2:
    s_add_u32 s3, s3, 1
    s_cmp_gt_u32 s3, 200000
    s_cbranch_scc1 L_or2_r
    s_sleep 2
    buffer_load_dwordx4 v[168:171], v3, s[40:43], s66 offen offset:2048 sc1
    s_waitcnt vmcnt(0)
    v_max3_u32 v11, v168, v169, v170
    v_max_u32 v11, v11, v171
    v_cmp_eq_u32 vcc, -1, v11
    s_nop 0
    s_cbranch_vccnz L_or2
    s_branch L_or2_r
L_or3:
    s_add_u32 s3, s3, 1
    s_cmp_gt_u32 s3, 200000
    s_cbranch_scc1 L_or3_r
    s_sleep 2
    buffer_load_dwordx4 v[172:175], v3, s[40:43], s66 offen offset:3072 sc1
    s_waitcnt vmcnt(0)
    v_max3_u32 v11, v172, v173, v174
    v_max_u32 v11, v11, v175
    v_cmp_eq_u32 vcc, -1, v11
    s_nop 0
    s_cbranch_vccnz L_or3
    s_branch L_or3_r
L_or4:
    s_add_u32 s3, s3, 1
    s_cmp_gt_u32 s3, 200000
    s_cbranch_scc1 L_or4_r
    s_sleep 2
    buffer_load_dwordx4 v[176:179], v3, s[40:43], s65 offen offset:0 sc1
    s_waitcnt vmcnt(0)
    v_max3_u32 v11, v176, v177, v178
    v_max_u32 v11, v11, v179
    v_cmp_eq_u32 vcc, -1, v11
    s_nop 0
    s_cbranch_vccnz L_or4
    s_branch L_or4_r
L_or5:
    s_add_u32 s3, s3, 1
    s_cmp_gt_u32 s3, 200000
    s_cbranch_scc1 L_or5_r
    s_sleep 2
    buffer_load_dwordx4 v[180:183], v3, s[40:43], s65 offen offset:1024 sc1
    s_waitcnt vmcnt(0)
    v_max3_u32 v11, v180, v181, v182
    v_max_u32 v11, v11, v183
    v_cmp_eq_u32 vcc, -1, v11
    s_nop 0
    s_cbranch_vccnz L_or5
    s_branch L_or5_r
L_or6:
    s_add_u32 s3, s3, 1
    s_cmp_gt_u32 s3, 200000
    s_cbranch_scc1 L_or6_r
    s_sleep 2
    buffer_load_dwordx4 v[184:187], v3, s[40:43], s65 offen offset:2048 sc1
    s_waitcnt vmcnt(0)
    v_max3_u32 v11, v184, v185, v186
    v_max_u32 v11, v11, v187
    v_cmp_eq_u32 vcc, -1, v11
    s_nop 0
    s_cbranch_vccnz L_or6
    s_branch L_or6_r
L_or7:
    s_add_u32 s3, s3, 1
    s_cmp_gt_u32 s3, 200000
    s_cbranch_scc1 L_or7_r
    s_sleep 2
    buffer_load_dwordx4 v[188:191], v3, s[40:43], s65 offen offset:3072 sc1
    s_waitcnt vmcnt(0)
    v_max3_u32 v11, v188, v189, v190
    v_max_u32 v11, v11, v191
    v_cmp_eq_u32 vcc, -1, v11
    s_nop 0
    s_cbranch_vccnz L_or7
    s_branch L_or7_r
L_spare:
    s_waitcnt vmcnt(14) lgkmcnt(0)
    s_barrier
    s_cmp_lt_u32 s44, 3
    s_cbranch_scc1 L_qfin_sp
L_qfin_r_sp:
    ds_read_b128 v[128:131], v7 offset:0
    ds_read_b64_tr_b16 v[120:121], v1 offset:0
    ds_read_b64_tr_b16 v[122:123], v1 offset:512
    ds_read_b128 v[136:139], v7 offset:32
    s_waitcnt lgkmcnt(0)
    ds_read_b64_tr_b16 v[124:125], v1 offset:2048
    ds_read_b64_tr_b16 v[126:127], v1 offset:2560
    s_barrier
    s_waitcnt lgkmcnt(0)
    s_waitcnt lgkmcnt(0)
    v_mfma_f32_32x32x16_bf16 v[80:95], v[120:123], v[128:131], 0
    s_nop 11
    s_add_u32 s99, s63, 1
    s_and_b32 s99, s99, 1
    s_add_u32 s99, s99, 1
    s_mul_i32 s65, s99, 229376
    s_add_u32 s65, s65, s54
    s_lshl_b32 s66, s99, 16
    s_add_u32 s66, s66, s55
    s_add_u32 m0, s59, 115264
    s_add_u32 s98, s65, 0
    buffer_load_dwordx4 v5, s[20:23], s98 offen lds
    s_add_u32 m0, s59, 131680
    s_add_u32 s98, s65, 0
    buffer_load_dwordx4 v5, s[24:27], s98 offen lds
    s_add_u32 m0, s59, 116288
    s_add_u32 s98, s65, 14336
    buffer_load_dwordx4 v5, s[20:23], s98 offen lds
    s_waitcnt lgkmcnt(0)
    s_waitcnt lgkmcnt(0)
    v_mfma_f32_32x32x16_bf16 v[80:95], v[124:127], v[136:139], v[80:95]
    s_nop 11
    s_add_u32 m0, s59, 132704
    s_add_u32 s98, s65, 14336
    buffer_load_dwordx4 v5, s[24:27], s98 offen lds
    s_add_u32 m0, s62, 148064
    s_add_u32 s98, s66, 0
    buffer_load_dwordx4 v6, s[8:11], s98 offen lds
    s_waitcnt vmcnt(5) lgkmcnt(0)
    s_barrier
    s_cmp_eq_u32 s44, 2
    s_cbranch_scc1 L_kvf_sp
L_kvf_r_sp:
    ds_read_b128 v[136:139], v7 offset:16640
    s_add_u32 s99, s63, 1
    s_and_b32 s99, s99, 1
    s_add_u32 s99, s99, 1
    s_lshl_b32 s64, s99, 7
    s_add_u32 s64, s64, s52
    s_add_u32 m0, s53, 0
    s_add_u32 s98, s64, 0
    buffer_load_dwordx4 v4, s[4:7], s98 offen lds
    v_add_u32 v192, 81984, v9
    v_add_u32 v193, 81984, v10
    v_add_u32 v194, 81984, v1
    s_add_u32 m0, s53, 1040
    s_add_u32 s98, s64, 1024
    buffer_load_dwordx4 v4, s[4:7], s98 offen lds
    ds_read_b64_tr_b16 v[120:121], v1 offset:40992
    ds_read_b64_tr_b16 v[122:123], v1 offset:41504
    ds_read_b128 v[144:147], v7 offset:16672
    s_add_u32 s99, s63, 0
    s_and_b32 s99, s99, 1
    s_add_u32 s99, s99, 3
    s_mul_i32 s65, s99, 229376
    s_add_u32 s65, s65, s54
    s_lshl_b32 s66, s99, 16
    s_add_u32 s66, s66, s55
    s_add_u32 m0, s59, 33280
    s_add_u32 s98, s65, 0
    buffer_load_dwordx4 v5, s[20:23], s98 offen lds
    s_add_u32 m0, s59, 49696
    s_add_u32 s98, s65, 0
    buffer_load_dwordx4 v5, s[24:27], s98 offen lds
    s_waitcnt lgkmcnt(0)
    ds_read_b64_tr_b16 v[124:125], v1 offset:43040
    ds_read_b64_tr_b16 v[126:127], v1 offset:43552
    s_waitcnt lgkmcnt(0)
    s_waitcnt lgkmcnt(0)
    v_mfma_f32_32x32x16_bf16 v[80:95], v[120:123], v[136:139], v[80:95]
    s_nop 11
    s_add_u32 m0, s59, 34304
    s_add_u32 s98, s65, 14336
    buffer_load_dwordx4 v5, s[20:23], s98 offen lds
    s_add_u32 m0, s59, 50720
    s_add_u32 s98, s65, 14336
    buffer_load_dwordx4 v5, s[24:27], s98 offen lds
    s_waitcnt lgkmcnt(0)
    s_waitcnt lgkmcnt(0)
    v_mfma_f32_32x32x16_bf16 v[80:95], v[124:127], v[144:147], v[80:95]
    s_nop 11
    s_add_u32 m0, s62, 66080
    s_add_u32 s98, s66, 0
    buffer_load_dwordx4 v6, s[8:11], s98 offen lds
    s_waitcnt vmcnt(5) lgkmcnt(0)
    s_barrier
    ds_read_b128 v[144:147], v7 offset:0
    s_add_u32 s99, s63, 0
    s_and_b32 s99, s99, 1
    s_add_u32 s99, s99, 3
    s_lshl_b32 s64, s99, 7
    s_add_u32 s64, s64, s52
    s_add_u32 m0, s53, 16640
    s_add_u32 s98, s64, 0
    buffer_load_dwordx4 v4, s[4:7], s98 offen lds
    s_add_u32 m0, s53, 17680
    s_add_u32 s98, s64, 1024
    buffer_load_dwordx4 v4, s[4:7], s98 offen lds
    ds_read_b64_tr_b16 v[120:121], v194 offset:0
    ds_read_b64_tr_b16 v[122:123], v194 offset:512
    ds_read_b128 v[128:131], v7 offset:32
    s_add_u32 s99, s63, 1
    s_and_b32 s99, s99, 1
    s_add_u32 s99, s99, 3
    s_mul_i32 s65, s99, 229376
    s_add_u32 s65, s65, s54
    s_lshl_b32 s66, s99, 16
    s_add_u32 s66, s66, s55
    s_add_u32 m0, s59, 74272
    s_add_u32 s98, s65, 0
    buffer_load_dwordx4 v5, s[20:23], s98 offen lds
    s_add_u32 m0, s59, 90688
    s_add_u32 s98, s65, 0
    buffer_load_dwordx4 v5, s[24:27], s98 offen lds
    s_waitcnt lgkmcnt(0)
    ds_read_b64_tr_b16 v[124:125], v194 offset:2048
    ds_read_b64_tr_b16 v[126:127], v194 offset:2560
    s_waitcnt lgkmcnt(0)
    s_waitcnt lgkmcnt(0)
    v_mfma_f32_32x32x16_bf16 v[80:95], v[120:123], v[144:147], v[80:95]
    s_nop 11
    s_add_u32 m0, s59, 75296
    s_add_u32 s98, s65, 14336
    buffer_load_dwordx4 v5, s[20:23], s98 offen lds
    s_add_u32 m0, s59, 91712
    s_add_u32 s98, s65, 14336
    buffer_load_dwordx4 v5, s[24:27], s98 offen lds
    s_waitcnt lgkmcnt(0)
    s_waitcnt lgkmcnt(0)
    v_mfma_f32_32x32x16_bf16 v[80:95], v[124:127], v[128:131], v[80:95]
    s_nop 11
    s_add_u32 m0, s62, 107072
    s_add_u32 s98, s66, 0
    buffer_load_dwordx4 v6, s[8:11], s98 offen lds
    s_waitcnt vmcnt(5) lgkmcnt(0)
    s_barrier
    ds_read_b128 v[128:131], v7 offset:16640
    s_add_u32 s99, s63, 1
    s_and_b32 s99, s99, 1
    s_add_u32 s99, s99, 3
    s_lshl_b32 s64, s99, 7
    s_add_u32 s64, s64, s52
    s_add_u32 m0, s53, 0
    s_add_u32 s98, s64, 0
    buffer_load_dwordx4 v4, s[4:7], s98 offen lds
    v_and_b32 v12, 27, v2
    v_cmp_eq_u32 vcc, 16, v12
    v_mov_b32 v12, 0x3f803f80
    s_nop 0
    v_cndmask_b32 v176, 0, v12, vcc
    v_mov_b32 v177, v176
    v_mov_b64 v[178:179], v[176:177]
    v_mov_b64 v[180:181], v[176:177]
    s_add_u32 m0, s53, 1040
    s_add_u32 s98, s64, 1024
    buffer_load_dwordx4 v4, s[4:7], s98 offen lds
    v_mov_b64 v[182:183], v[176:177]
    v_mov_b64 v[184:185], v[176:177]
    ds_read_b64_tr_b16 v[120:121], v1 offset:0
    ds_read_b64_tr_b16 v[122:123], v1 offset:512
    v_mov_b64 v[186:187], v[176:177]
    v_mov_b64 v[188:189], v[176:177]
    ds_read_b128 v[136:139], v7 offset:16672
    s_add_u32 s99, s63, 0
    s_mul_i32 s98, s99, 21846
    s_lshr_b32 s98, s98, 16
    s_mul_i32 s98, s98, 3
    s_sub_u32 s99, s99, s98
    s_add_u32 s99, s99, 5
    s_mul_i32 s65, s99, 229376
    s_add_u32 s65, s65, s54
    s_lshl_b32 s66, s99, 16
    s_add_u32 s66, s66, s55
    s_add_u32 m0, s59, 115264
    s_add_u32 s98, s65, 0
    buffer_load_dwordx4 v5, s[20:23], s98 offen lds
    v_mov_b64 v[190:191], v[176:177]
    v_mov_b64 v[160:161], 0
    v_mov_b64 v[162:163], 0
    v_mov_b64 v[164:165], 0
    s_add_u32 m0, s59, 131680
    s_add_u32 s98, s65, 0
    buffer_load_dwordx4 v5, s[24:27], s98 offen lds
    v_mov_b64 v[166:167], 0
    v_mov_b64 v[168:169], 0
    s_waitcnt lgkmcnt(0)
    ds_read_b64_tr_b16 v[124:125], v1 offset:2048
    ds_read_b64_tr_b16 v[126:127], v1 offset:2560
    v_mov_b64 v[170:171], 0
    v_mov_b64 v[172:173], 0
    s_waitcnt lgkmcnt(0)
    s_waitcnt lgkmcnt(0)
    v_mfma_f32_32x32x16_bf16 v[80:95], v[120:123], v[128:131], v[80:95]
    s_nop 11
    v_mov_b64 v[174:175], 0
    v_mov_b64 v[200:201], 0
    s_add_u32 m0, s59, 116288
    s_add_u32 s98, s65, 14336
    buffer_load_dwordx4 v5, s[20:23], s98 offen lds
    v_mov_b64 v[202:203], 0
    v_mov_b64 v[204:205], 0
    v_mov_b64 v[206:207], 0
    v_mov_b64 v[208:209], 0
    s_add_u32 m0, s59, 132704
    s_add_u32 s98, s65, 14336
    buffer_load_dwordx4 v5, s[24:27], s98 offen lds
    v_mov_b64 v[210:211], 0
    v_mov_b64 v[212:213], 0
    v_mov_b64 v[214:215], 0
    v_mov_b32 v232, s50
    s_waitcnt lgkmcnt(0)
    s_waitcnt lgkmcnt(0)
    v_mfma_f32_32x32x16_bf16 v[80:95], v[124:127], v[136:139], v[80:95]
    s_nop 11
    s_add_u32 m0, s62, 148064
    s_add_u32 s98, s66, 0
    buffer_load_dwordx4 v6, s[8:11], s98 offen lds
    v_mov_b32 v233, s50
    v_mov_b32 v234, s51
    v_mov_b32 v235, s51
    s_waitcnt vmcnt(5) lgkmcnt(0)
    s_barrier
    ds_read_b128 v[136:139], v7 offset:0
    s_add_u32 s99, s63, 0
    s_mul_i32 s98, s99, 21846
    s_lshr_b32 s98, s98, 16
    s_mul_i32 s98, s98, 3
    s_sub_u32 s99, s99, s98
    s_add_u32 s99, s99, 5
    s_lshl_b32 s64, s99, 7
    s_add_u32 s64, s64, s52
    s_add_u32 m0, s53, 16640
    s_add_u32 s98, s64, 0
    buffer_load_dwordx4 v4, s[4:7], s98 offen lds
    s_add_u32 m0, s53, 17680
    s_add_u32 s98, s64, 1024
    buffer_load_dwordx4 v4, s[4:7], s98 offen lds
    ds_read_b64_tr_b16 v[120:121], v1 offset:40992
    ds_read_b64_tr_b16 v[122:123], v1 offset:41504
    ds_read_b128 v[144:147], v7 offset:32
    s_add_u32 s99, s63, 1
    s_mul_i32 s98, s99, 21846
    s_lshr_b32 s98, s98, 16
    s_mul_i32 s98, s98, 3
    s_sub_u32 s99, s99, s98
    s_add_u32 s99, s99, 5
    s_mul_i32 s65, s99, 229376
    s_add_u32 s65, s65, s54
    s_lshl_b32 s66, s99, 16
    s_add_u32 s66, s66, s55
    s_add_u32 m0, s59, 33280
    s_add_u32 s98, s65, 0
    buffer_load_dwordx4 v5, s[20:23], s98 offen lds
    s_add_u32 m0, s59, 49696
    s_add_u32 s98, s65, 0
    buffer_load_dwordx4 v5, s[24:27], s98 offen lds
    s_waitcnt lgkmcnt(0)
    ds_read_b64_tr_b16 v[124:125], v1 offset:43040
    ds_read_b64_tr_b16 v[126:127], v1 offset:43552
    s_waitcnt lgkmcnt(0)
    s_waitcnt lgkmcnt(0)
    v_mfma_f32_32x32x16_bf16 v[80:95], v[120:123], v[136:139], v[80:95]
    s_nop 11
    s_add_u32 m0, s59, 34304
    s_add_u32 s98, s65, 14336
    buffer_load_dwordx4 v5, s[20:23], s98 offen lds
    s_add_u32 m0, s59, 50720
    s_add_u32 s98, s65, 14336
    buffer_load_dwordx4 v5, s[24:27], s98 offen lds
    s_waitcnt lgkmcnt(0)
    s_waitcnt lgkmcnt(0)
    v_mfma_f32_32x32x16_bf16 v[80:95], v[124:127], v[144:147], v[80:95]
    s_nop 11
    s_add_u32 m0, s62, 66080
    s_add_u32 s98, s66, 0
    buffer_load_dwordx4 v6, s[8:11], s98 offen lds
    s_waitcnt vmcnt(5) lgkmcnt(0)
    s_barrier
    s_cmp_eq_u32 s44, 1
    s_cbranch_scc1 L_kvi_sp
L_kvi_r_sp:
    ds_read_b128 v[144:147], v7 offset:16640
    s_add_u32 s99, s63, 1
    s_mul_i32 s98, s99, 21846
    s_lshr_b32 s98, s98, 16
    s_mul_i32 s98, s98, 3
    s_sub_u32 s99, s99, s98
    s_add_u32 s99, s99, 5
    s_lshl_b32 s64, s99, 7
    s_add_u32 s64, s64, s52
    s_add_u32 m0, s53, 0
    s_add_u32 s98, s64, 0
    buffer_load_dwordx4 v4, s[4:7], s98 offen lds
    s_add_u32 m0, s53, 1040
    s_add_u32 s98, s64, 1024
    buffer_load_dwordx4 v4, s[4:7], s98 offen lds
    ds_read_b64_tr_b16 v[120:121], v194 offset:0
    ds_read_b64_tr_b16 v[122:123], v194 offset:512
    ds_read_b128 v[128:131], v7 offset:16672
    s_add_u32 s99, s63, 2
    s_mul_i32 s98, s99, 21846
    s_lshr_b32 s98, s98, 16
    s_mul_i32 s98, s98, 3
    s_sub_u32 s99, s99, s98
    s_add_u32 s99, s99, 5
    s_mul_i32 s65, s99, 229376
    s_add_u32 s65, s65, s54
    s_lshl_b32 s66, s99, 16
    s_add_u32 s66, s66, s55
    s_add_u32 m0, s59, 74272
    s_add_u32 s98, s65, 0
    buffer_load_dwordx4 v5, s[20:23], s98 offen lds
    s_add_u32 m0, s59, 90688
    s_add_u32 s98, s65, 0
    buffer_load_dwordx4 v5, s[24:27], s98 offen lds
    s_waitcnt lgkmcnt(0)
    ds_read_b64_tr_b16 v[124:125], v194 offset:2048
    ds_read_b64_tr_b16 v[126:127], v194 offset:2560
    s_waitcnt lgkmcnt(0)
    s_waitcnt lgkmcnt(0)
    v_mfma_f32_32x32x16_bf16 v[80:95], v[120:123], v[144:147], v[80:95]
    s_nop 11
    s_add_u32 m0, s59, 75296
    s_add_u32 s98, s65, 14336
    buffer_load_dwordx4 v5, s[20:23], s98 offen lds
    s_add_u32 m0, s59, 91712
    s_add_u32 s98, s65, 14336
    buffer_load_dwordx4 v5, s[24:27], s98 offen lds
    s_waitcnt lgkmcnt(0)
    s_waitcnt lgkmcnt(0)
    v_mfma_f32_32x32x16_bf16 v[80:95], v[124:127], v[128:131], v[80:95]
    s_nop 11
    s_add_u32 m0, s62, 107072
    s_add_u32 s98, s66, 0
    buffer_load_dwordx4 v6, s[8:11], s98 offen lds
    s_cmp_eq_u32 s44, 1
    s_cbranch_scc1 L_kvc_sp
L_kvc_r_sp:
    s_waitcnt vmcnt(5) lgkmcnt(0)
    s_barrier
    ds_read_b128 v[128:131], v7 offset:0
    s_add_u32 s99, s63, 2
    s_mul_i32 s98, s99, 21846
    s_lshr_b32 s98, s98, 16
    s_mul_i32 s98, s98, 3
    s_sub_u32 s99, s99, s98
    s_add_u32 s99, s99, 5
    s_lshl_b32 s64, s99, 7
    s_add_u32 s64, s64, s52
    s_add_u32 m0, s53, 16640
    s_add_u32 s98, s64, 0
    buffer_load_dwordx4 v4, s[4:7], s98 offen lds
    v_lshrrev_b32 v13, 5, v2
    v_lshlrev_b32 v13, 9, v13
    v_bfe_u32 v12, v2, 2, 2
    v_lshl_add_u32 v13, v12, 7, v13
    s_add_u32 m0, s53, 17680
    s_add_u32 s98, s64, 1024
    buffer_load_dwordx4 v4, s[4:7], s98 offen lds
    v_bfe_u32 v12, v2, 3, 1
    v_lshl_add_u32 v13, v12, 6, v13
    ds_read_b64_tr_b16 v[120:121], v1 offset:0
    ds_read_b64_tr_b16 v[122:123], v1 offset:512
    v_bfe_u32 v12, v2, 4, 1
    v_lshl_add_u32 v13, v12, 5, v13
    ds_read_b128 v[136:139], v7 offset:32
    v_and_b32 v12, 3, v2
    v_lshl_add_u32 v5, v12, 3, v13
    s_add_u32 m0, s62, 131072
    s_add_u32 s98, s62, 0
    buffer_load_dwordx4 v3, s[40:43], s98 offen sc1 lds
    s_lshr_b32 s99, s44, 1
    s_lshl_b32 s100, s99, 13
    v_add_u32 v5, s100, v5
    s_waitcnt lgkmcnt(0)
    ds_read_b64_tr_b16 v[124:125], v1 offset:2048
    ds_read_b64_tr_b16 v[126:127], v1 offset:2560
    s_waitcnt lgkmcnt(0)
    s_waitcnt lgkmcnt(0)
    v_mfma_f32_32x32x16_bf16 v[80:95], v[120:123], v[128:131], v[80:95]
    s_nop 11
    s_add_u32 m0, s62, 139264
    s_add_u32 s98, s62, 8192
    buffer_load_dwordx4 v3, s[40:43], s98 offen sc1 lds
    s_add_u32 m0, s62, 147456
    s_add_u32 s98, s62, 16384
    buffer_load_dwordx4 v3, s[40:43], s98 offen sc1 lds
    s_waitcnt lgkmcnt(0)
    s_waitcnt lgkmcnt(0)
    v_mfma_f32_32x32x16_bf16 v[80:95], v[124:127], v[136:139], v[80:95]
    s_nop 11
    s_add_u32 m0, s62, 155648
    s_add_u32 s98, s62, 24576
    buffer_load_dwordx4 v3, s[40:43], s98 offen sc1 lds
    s_waitcnt vmcnt(4) lgkmcnt(0)
    s_barrier
    s_cmp_eq_u32 s44, 1
    s_cbranch_scc1 L_kvn_sp
L_kvn_r_sp:
    ds_read_b128 v[136:139], v7 offset:16640
    v_mov_b64 v[236:237], -1
    v_mov_b64 v[238:239], -1
    buffer_store_dwordx4 v[236:239], v3, s[40:43], s57 offen sc1
    ds_read_b64_tr_b16 v[120:121], v1 offset:40992
    ds_read_b64_tr_b16 v[122:123], v1 offset:41504
    ds_read_b128 v[144:147], v7 offset:16672
    s_waitcnt lgkmcnt(0)
    ds_read_b64_tr_b16 v[124:125], v1 offset:43040
    ds_read_b64_tr_b16 v[126:127], v1 offset:43552
    s_waitcnt lgkmcnt(0)
    s_waitcnt lgkmcnt(0)
    v_mfma_f32_32x32x16_bf16 v[80:95], v[120:123], v[136:139], v[80:95]
    s_nop 11
    s_waitcnt lgkmcnt(0)
    s_waitcnt lgkmcnt(0)
    v_mfma_f32_32x32x16_bf16 v[80:95], v[124:127], v[144:147], v[80:95]
    s_nop 11
    s_waitcnt lgkmcnt(0)
    s_lshl_b32 s99, s44, 12
    s_add_u32 s99, s99, 40960
    v_add_u32 v11, s99, v3
    ds_write_b128 v11, v[80:83] offset:0
    ds_write_b128 v11, v[84:87] offset:1024
    ds_write_b128 v11, v[88:91] offset:2048
    ds_write_b128 v11, v[92:95] offset:3072
    s_waitcnt lgkmcnt(0)
    s_and_b32 s99, s44, 3
    s_lshl_b32 s99, s99, 12
    s_lshl_b32 s100, s45, 11
    s_add_u32 s99, s99, s100
    s_add_u32 s99, s99, 40960
    v_add_u32 v11, s99, v3
    v_add_u32 v0, s100, v3
    v_mov_b32 v15, 0xdddddddd
    v_add_u32 v1, 65536, v0
    v_add_u32 v127, 131072, v0
    s_bitcmp1_b32 s46, 0
    s_cselect_b32 s99, -147456, 0
    s_cselect_b32 s100, 0, 147456
    s_add_u32 s52, s56, s99
    s_add_u32 s52, s52, s100
    s_add_u32 s99, s56, 0
    buffer_store_dwordx4 v[236:239], v3, s[40:43], s99 offen sc1
    s_add_u32 s99, s56, 1024
    buffer_store_dwordx4 v[236:239], v3, s[40:43], s99 offen sc1
    s_waitcnt lgkmcnt(0)
    s_barrier
    ds_read_b128 v[240:243], v11
    ds_read_b128 v[244:247], v11 offset:1024
    ds_read_b128 v[248:251], v11 offset:16384
    ds_read_b128 v[252:255], v11 offset:17408
    s_add_u32 m0, s62, 0
    s_add_u32 s98, s62, 32768
    buffer_load_dwordx4 v3, s[40:43], s98 offen sc1 lds
    s_add_u32 m0, s62, 8192
    s_add_u32 s98, s62, 40960
    buffer_load_dwordx4 v3, s[40:43], s98 offen sc1 lds
    s_add_u32 m0, s62, 16384
    s_add_u32 s98, s62, 49152
    buffer_load_dwordx4 v3, s[40:43], s98 offen sc1 lds
    s_add_u32 m0, s62, 24576
    s_add_u32 s98, s62, 57344
    buffer_load_dwordx4 v3, s[40:43], s98 offen sc1 lds
    s_add_u32 s99, s52, 0
    buffer_store_dwordx4 v[236:239], v3, s[40:43], s99 offen sc1
    s_waitcnt lgkmcnt(0)
    s_mov_b32 s101, 1052289595
    v_pk_add_f32 v[240:241], v[240:241], v[248:249]
    v_pk_add_f32 v[242:243], v[242:243], v[250:251]
    v_pk_add_f32 v[244:245], v[244:245], v[252:253]
    v_pk_add_f32 v[246:247], v[246:247], v[254:255]
    v_mul_f32 v240, s101, v240
    v_mul_f32 v241, s101, v241
    v_mul_f32 v242, s101, v242
    v_mul_f32 v243, s101, v243
    v_mul_f32 v244, s101, v244
    v_mul_f32 v245, s101, v245
    v_mul_f32 v246, s101, v246
    v_mul_f32 v247, s101, v247
    v_cvt_pk_bf16_f32 v120, v240, v241
    v_cvt_pk_bf16_f32 v121, v242, v243
    v_cvt_pk_bf16_f32 v122, v244, v245
    v_cvt_pk_bf16_f32 v123, v246, v247
    v_mul_f32 v124, v240, v240
    v_fmac_f32 v124, v241, v241
    v_fmac_f32 v124, v242, v242
    v_fmac_f32 v124, v243, v243
    v_fmac_f32 v124, v244, v244
    v_fmac_f32 v124, v245, v245
    v_fmac_f32 v124, v246, v246
    v_fmac_f32 v124, v247, v247
    v_mov_b32 v12, v124
    s_lshl_b32 s99, s44, 11
    s_add_u32 s99, s99, 98304
    v_add_u32 v13, s99, v3
    v_permlane32_swap_b32 v124, v12
    v_mov_b32 v11, 120000
    v_add_f32 v124, v124, v12
    ds_write_b128 v13, v[120:123]
    ds_write_b32 v13, v124 offset:1024
    v_xor_b32 v13, 8192, v13
    s_setprio 3
    s_waitcnt vmcnt(8) lgkmcnt(0)
    s_barrier
    ds_read_b32 v125, v11
    ds_read_b128 v[192:195], v127 offset:0
    ds_read_b32 v4, v13 offset:1024
    ds_read_b128 v[196:199], v13
    s_mov_b64 exec, s[60:61]
    ds_read_b128 v[176:179], v127 offset:1024
    ds_read_b128 v[180:183], v127 offset:1280
    s_mov_b64 exec, -1
    s_waitcnt lgkmcnt(0)
    s_waitcnt lgkmcnt(0)
    v_mfma_f32_32x32x16_bf16 v[16:31], v[192:195], v[120:123], 0
    s_nop 11
    v_max_f32 v124, v124, v4
    v_mul_f32 v124, v124, v125
    s_mov_b32 s100, 1158676480
    v_cmp_nge_f32 vcc, s100, v124
    s_add_u32 s99, s52, 1024
    buffer_store_dwordx4 v[236:239], v3, s[40:43], s99 offen sc1
    s_branch L_join
L_qfin_sp:
    s_cmp_eq_u32 s44, 1
    s_cbranch_scc1 L_qf1_sp
    s_cmp_eq_u32 s44, 2
    s_cbranch_scc1 L_qf2_sp
    v_add_u32 v70, 115264, v3
    ds_read_b128 v[48:51], v70 offset:0
    ds_read_b128 v[52:55], v70 offset:9344
    ds_read_b128 v[56:59], v70 offset:18688
    ds_read_b128 v[60:63], v70 offset:28032
    v_and_b32 v13, 15, v2
    v_lshrrev_b32 v14, 4, v2
    s_lshr_b32 s100, s48, 2
    s_lshl_b32 s101, s47, 2
    s_add_u32 s100, s100, s101
    s_lshl_b32 s100, s100, 11
    s_lshr_b32 s101, s48, 1
    s_and_b32 s101, s101, 1
    s_lshl_b32 s101, s101, 8
    s_add_u32 s100, s100, s101
    v_and_b32 v11, 1, v14
    v_lshrrev_b32 v12, 1, v14
    s_and_b32 s99, s48, 1
    s_lshl_b32 s101, s99, 10
    s_add_u32 s100, s100, s101
    s_cmp_eq_u32 s99, 1
    s_cselect_b64 vcc, -1, 0
    v_cndmask_b32 v68, v11, v12, vcc
    v_cndmask_b32 v69, v12, v11, vcc
    v_lshlrev_b32 v11, 9, v68
    v_lshl_add_u32 v11, v13, 4, v11
    v_lshl_add_u32 v11, v69, 3, v11
    s_waitcnt lgkmcnt(0)
    v_add_f32 v48, v48, v52
    v_add_f32 v56, v56, v60
    v_add_f32 v49, v49, v53
    v_add_f32 v57, v57, v61
    v_add_f32 v50, v50, v54
    v_add_f32 v58, v58, v62
    v_add_f32 v51, v51, v55
    v_add_f32 v59, v59, v63
    v_add_f32 v48, v48, v56
    v_add_f32 v49, v49, v57
    v_add_f32 v50, v50, v58
    v_add_f32 v51, v51, v59
    v_cvt_pk_bf16_f32 v52, v48, v49
    v_cvt_pk_bf16_f32 v53, v50, v51
    buffer_store_dwordx2 v[52:53], v11, s[40:43], s100 offen sc1
    s_branch L_qfin_r_sp
L_qf1_sp:
    v_add_u32 v70, 115264, v3
    ds_read_b32 v64, v70 offset:1024
    ds_read_b32 v65, v70 offset:10368
    ds_read_b32 v66, v70 offset:19712
    ds_read_b32 v67, v70 offset:29056
    s_lshl_b32 s100, s47, 9
    s_lshr_b32 s101, s48, 1
    s_lshl_b32 s101, s101, 6
    s_add_u32 s100, s100, s101
    s_add_u32 s100, s100, 131072
    s_bitcmp1_b32 s48, 0
    s_cselect_b32 s100, 0x40000000, s100
    v_and_b32 v11, 15, v2
    v_lshlrev_b32 v11, 2, v11
    s_waitcnt lgkmcnt(0)
    v_add_f32 v64, v64, v65
    v_add_f32 v66, v66, v67
    v_add_f32 v64, v64, v66
    buffer_store_dword v64, v11, s[40:43], s100 offen sc1
    s_branch L_qfin_r_sp
L_qf2_sp:
    v_add_u32 v70, 115264, v3
    ds_read_b128 v[48:51], v70 offset:0
    ds_read_b128 v[52:55], v70 offset:9344
    ds_read_b128 v[56:59], v70 offset:18688
    ds_read_b128 v[60:63], v70 offset:28032
    s_waitcnt lgkmcnt(0)
    v_add_f32 v48, v48, v52
    v_add_f32 v56, v56, v60
    v_add_f32 v49, v49, v53
    v_add_f32 v57, v57, v61
    v_add_f32 v50, v50, v54
    v_add_f32 v58, v58, v62
    v_add_f32 v51, v51, v55
    v_add_f32 v59, v59, v63
    v_add_f32 v48, v48, v56
    v_add_f32 v49, v49, v57
    v_add_f32 v50, v50, v58
    v_add_f32 v51, v51, v59
    v_mul_f32 v54, v48, v48
    v_fmac_f32 v54, v49, v49
    v_fmac_f32 v54, v50, v50
    v_fmac_f32 v54, v51, v51
    v_mov_b32 v55, v54
    s_nop 1
    v_permlane16_swap_b32 v54, v55
    s_nop 0
    v_add_f32 v54, v54, v55
    v_mov_b32 v55, v54
    s_nop 1
    v_permlane32_swap_b32 v54, v55
    s_nop 0
    v_add_f32 v54, v54, v55
    s_nop 1
    v_max_f32_dpp v54, v54, v54 row_ror:8 row_mask:0xf bank_mask:0xf
    s_nop 1
    v_max_f32_dpp v54, v54, v54 row_ror:4 row_mask:0xf bank_mask:0xf
    s_nop 1
    v_max_f32_dpp v54, v54, v54 row_ror:2 row_mask:0xf bank_mask:0xf
    s_nop 1
    v_max_f32_dpp v54, v54, v54 row_ror:1 row_mask:0xf bank_mask:0xf
    s_bitcmp1_b32 s48, 0
    s_cselect_b64 vcc, -1, 0
    v_cndmask_b32 v253, v54, 0, vcc
    s_branch L_qfin_r_sp
L_kvf_sp:
    v_mov_b32 v252, s49
    s_lshl_b32 s99, s67, 4
    s_add_u32 s99, s99, 147456
    v_mov_b32 v11, 0
    s_mov_b64 exec, 1
    buffer_store_dwordx2 v[252:253], v11, s[40:43], s99 offen sc1
    s_mov_b64 exec, -1
    s_branch L_kvf_r_sp
L_kvi_sp:
    s_mov_b32 s99, 147456
    buffer_load_dwordx2 v[240:241], v3, s[40:43], s99 offen offset:0 sc1
    buffer_load_dwordx2 v[242:243], v3, s[40:43], s99 offen offset:1024 sc1
    buffer_load_dwordx2 v[244:245], v3, s[40:43], s99 offen offset:2048 sc1
    buffer_load_dwordx2 v[246:247], v3, s[40:43], s99 offen offset:3072 sc1
    s_branch L_kvi_r_sp
L_kvc_sp:
    s_waitcnt vmcnt(7)
L_kvp_chk_sp:
    v_cmp_ne_u32 vcc, s49, v240
    v_cmp_ne_u32 s[100:101], s49, v242
    s_nop 0
    s_or_b64 vcc, vcc, s[100:101]
    v_cmp_ne_u32 s[100:101], s49, v244
    s_nop 0
    s_or_b64 vcc, vcc, s[100:101]
    v_cmp_ne_u32 s[100:101], s49, v246
    s_nop 0
    s_or_b64 vcc, vcc, s[100:101]
    s_cbranch_vccz L_kvp_ok_sp
    s_add_u32 s3, s3, 1
    s_cmp_gt_u32 s3, 200000
    s_cbranch_scc1 L_kvp_ok_sp
    s_sleep 16
    s_mov_b32 s99, 147456
    buffer_load_dwordx2 v[240:241], v3, s[40:43], s99 offen offset:0 sc1
    buffer_load_dwordx2 v[242:243], v3, s[40:43], s99 offen offset:1024 sc1
    buffer_load_dwordx2 v[244:245], v3, s[40:43], s99 offen offset:2048 sc1
    buffer_load_dwordx2 v[246:247], v3, s[40:43], s99 offen offset:3072 sc1
    s_waitcnt vmcnt(0)
    s_branch L_kvp_chk_sp
L_kvp_ok_sp:
    v_max_f32 v241, v241, v243
    v_max3_f32 v248, v241, v245, v247
    v_lshlrev_b32 v13, 7, v2
    s_lshr_b32 s99, s2, 3
    s_lshl_b32 s99, s99, 12
    s_mov_b64 exec, 0xffffffff
    buffer_load_dword v195, v13, s[40:43], s99 offen sc1
    s_mov_b64 exec, -1
    s_branch L_kvc_r_sp
L_kvn_sp:
    v_mov_b32 v249, v248
    s_nop 1
    v_permlane16_swap_b32 v248, v249
    s_nop 0
    v_max_f32 v248, v248, v249
    v_mov_b32 v249, v248
    s_nop 1
    v_permlane32_swap_b32 v248, v249
    s_nop 0
    v_max_f32 v248, v248, v249
    s_nop 1
    v_max_f32_dpp v248, v248, v248 row_ror:8 row_mask:0xf bank_mask:0xf
    s_nop 1
    v_max_f32_dpp v248, v248, v248 row_ror:4 row_mask:0xf bank_mask:0xf
    s_nop 1
    v_max_f32_dpp v248, v248, v248 row_ror:2 row_mask:0xf bank_mask:0xf
    s_nop 1
    v_max_f32_dpp v248, v248, v248 row_ror:1 row_mask:0xf bank_mask:0xf
    v_mov_b32 v249, 120000
    ds_write_b32 v249, v248
    s_cmp_lg_u32 s2, 0
    s_cbranch_scc1 L_kvp_end_sp
    v_mov_b32 v249, s49
    v_mov_b32 v248, 139264
    s_mov_b64 exec, 1
    buffer_store_dword v249, v248, s[40:43], 0 offen sc1
    s_mov_b64 exec, -1
L_kvp_end_sp:
    s_branch L_kvn_r_sp
L_slow:
    v_mov_b32 v125, 0xff800000
    v_mov_b32 v4, 0xff800000
    s_mov_b32 s99, 0
L_pre_loop:
    buffer_load_dwordx4 v[48:51], v3, s[40:43], s99 offen sc1
    s_waitcnt vmcnt(0)
    v_mfma_f32_32x32x16_bf16 v[64:79], v[48:51], v[120:123], 0
    v_mfma_f32_32x32x16_bf16 v[80:95], v[48:51], v[196:199], 0
    s_nop 11
    v_max3_f32 v125, v125, v64, v65
    v_max3_f32 v125, v125, v66, v67
    v_max3_f32 v125, v125, v68, v69
    v_max3_f32 v125, v125, v70, v71
    v_max3_f32 v125, v125, v72, v73
    v_max3_f32 v125, v125, v74, v75
    v_max3_f32 v125, v125, v76, v77
    v_max3_f32 v125, v125, v78, v79
    v_max3_f32 v4, v4, v80, v81
    v_max3_f32 v4, v4, v82, v83
    v_max3_f32 v4, v4, v84, v85
    v_max3_f32 v4, v4, v86, v87
    v_max3_f32 v4, v4, v88, v89
    v_max3_f32 v4, v4, v90, v91
    v_max3_f32 v4, v4, v92, v93
    v_max3_f32 v4, v4, v94, v95
    s_add_u32 s99, s99, 2048
    s_cmp_lt_u32 s99, 131072
    s_cbranch_scc1 L_pre_loop
    v_mov_b32 v11, v125
    v_mov_b32 v12, v4
    s_nop 1
    v_permlane32_swap_b32 v125, v11
    v_permlane32_swap_b32 v4, v12
    s_nop 0
    v_max_f32 v125, v125, v11
    v_max_f32 v4, v4, v12
    s_setprio 3
    v_sub_f32 v16, v16, v125
    v_exp_f32 v16, v16
    v_sub_f32 v17, v17, v125
    v_exp_f32 v17, v17
    v_sub_f32 v18, v18, v125
    v_exp_f32 v18, v18
    s_mov_b64 exec, s[60:61]
    ds_read_b128 v[184:187], v127 offset:5120
    ds_read_b128 v[188:191], v127 offset:5376
    s_mov_b64 exec, -1
    v_sub_f32 v19, v19, v125
    v_exp_f32 v19, v19
    v_sub_f32 v20, v20, v125
    v_exp_f32 v20, v20
    v_sub_f32 v21, v21, v125
    v_exp_f32 v21, v21
    v_mfma_f32_32x32x16_bf16 v[32:47], v[192:195], v[196:199], 0
    ds_read_b128 v[192:195], v127 offset:4096
    v_sub_f32 v22, v22, v125
    v_exp_f32 v22, v22
    v_sub_f32 v23, v23, v125
    v_exp_f32 v23, v23
    v_sub_f32 v24, v24, v125
    v_exp_f32 v24, v24
    v_sub_f32 v25, v25, v125
    v_exp_f32 v25, v25
    v_smfmac_f32_32x32x32_bf16 v[160:175], v[176:179], v[16:23], v15
    s_add_u32 m0, s62, 32768
    s_add_u32 s98, s62, 65536
    buffer_load_dwordx4 v3, s[40:43], s98 offen sc1 lds
    v_sub_f32 v26, v26, v125
    v_exp_f32 v26, v26
    v_sub_f32 v27, v27, v125
    v_exp_f32 v27, v27
    v_sub_f32 v28, v28, v125
    v_exp_f32 v28, v28
    v_sub_f32 v29, v29, v125
    v_exp_f32 v29, v29
    v_sub_f32 v30, v30, v125
    v_exp_f32 v30, v30
    v_sub_f32 v31, v31, v125
    v_exp_f32 v31, v31
    s_setprio 2
    v_sub_f32 v32, v32, v4
    v_exp_f32 v32, v32
    v_sub_f32 v33, v33, v4
    v_exp_f32 v33, v33
    v_sub_f32 v34, v34, v4
    v_exp_f32 v34, v34
    v_smfmac_f32_32x32x32_bf16 v[160:175], v[180:183], v[24:31], v15
    v_sub_f32 v35, v35, v4
    v_exp_f32 v35, v35
    v_sub_f32 v36, v36, v4
    v_exp_f32 v36, v36
    v_sub_f32 v37, v37, v4
    v_exp_f32 v37, v37
    s_waitcnt lgkmcnt(0)
    v_mfma_f32_32x32x16_bf16 v[16:31], v[192:195], v[120:123], 0
    v_sub_f32 v38, v38, v4
    v_exp_f32 v38, v38
    v_sub_f32 v39, v39, v4
    v_exp_f32 v39, v39
    v_sub_f32 v40, v40, v4
    v_exp_f32 v40, v40
    v_sub_f32 v41, v41, v4
    v_exp_f32 v41, v41
    v_smfmac_f32_32x32x32_bf16 v[200:215], v[176:179], v[32:39], v15
    s_add_u32 m0, s62, 40960
    s_add_u32 s98, s62, 73728
    buffer_load_dwordx4 v3, s[40:43], s98 offen sc1 lds
    v_sub_f32 v42, v42, v4
    v_exp_f32 v42, v42
    v_sub_f32 v43, v43, v4
    v_exp_f32 v43, v43
    v_sub_f32 v44, v44, v4
    v_exp_f32 v44, v44
    v_sub_f32 v45, v45, v4
    v_exp_f32 v45, v45
    v_sub_f32 v46, v46, v4
    v_exp_f32 v46, v46
    v_sub_f32 v47, v47, v4
    v_exp_f32 v47, v47
    s_setprio 1
    v_sub_f32 v16, v16, v125
    v_exp_f32 v16, v16
    v_sub_f32 v17, v17, v125
    v_exp_f32 v17, v17
    v_sub_f32 v18, v18, v125
    v_exp_f32 v18, v18
    v_smfmac_f32_32x32x32_bf16 v[200:215], v[180:183], v[40:47], v15
    s_mov_b64 exec, s[60:61]
    ds_read_b128 v[176:179], v127 offset:9216
    ds_read_b128 v[180:183], v127 offset:9472
    s_mov_b64 exec, -1
    v_sub_f32 v19, v19, v125
    v_exp_f32 v19, v19
    v_sub_f32 v20, v20, v125
    v_exp_f32 v20, v20
    v_sub_f32 v21, v21, v125
    v_exp_f32 v21, v21
    v_mfma_f32_32x32x16_bf16 v[32:47], v[192:195], v[196:199], 0
    ds_read_b128 v[192:195], v127 offset:8192
    v_sub_f32 v22, v22, v125
    v_exp_f32 v22, v22
    v_sub_f32 v23, v23, v125
    v_exp_f32 v23, v23
    v_sub_f32 v24, v24, v125
    v_exp_f32 v24, v24
    v_sub_f32 v25, v25, v125
    v_exp_f32 v25, v25
    v_smfmac_f32_32x32x32_bf16 v[160:175], v[184:187], v[16:23], v15
    s_add_u32 m0, s62, 49152
    s_add_u32 s98, s62, 81920
    buffer_load_dwordx4 v3, s[40:43], s98 offen sc1 lds
    v_sub_f32 v26, v26, v125
    v_exp_f32 v26, v26
    v_sub_f32 v27, v27, v125
    v_exp_f32 v27, v27
    v_sub_f32 v28, v28, v125
    v_exp_f32 v28, v28
    v_sub_f32 v29, v29, v125
    v_exp_f32 v29, v29
    v_sub_f32 v30, v30, v125
    v_exp_f32 v30, v30
    v_sub_f32 v31, v31, v125
    v_exp_f32 v31, v31
    s_setprio 0
    v_sub_f32 v32, v32, v4
    v_exp_f32 v32, v32
    v_sub_f32 v33, v33, v4
    v_exp_f32 v33, v33
    v_sub_f32 v34, v34, v4
    v_exp_f32 v34, v34
    v_smfmac_f32_32x32x32_bf16 v[160:175], v[188:191], v[24:31], v15
    v_sub_f32 v35, v35, v4
    v_exp_f32 v35, v35
    v_sub_f32 v36, v36, v4
    v_exp_f32 v36, v36
    v_sub_f32 v37, v37, v4
    v_exp_f32 v37, v37
    s_waitcnt lgkmcnt(0)
    v_mfma_f32_32x32x16_bf16 v[16:31], v[192:195], v[120:123], 0
    v_sub_f32 v38, v38, v4
    v_exp_f32 v38, v38
    v_sub_f32 v39, v39, v4
    v_exp_f32 v39, v39
    v_sub_f32 v40, v40, v4
    v_exp_f32 v40, v40
    v_sub_f32 v41, v41, v4
    v_exp_f32 v41, v41
    v_smfmac_f32_32x32x32_bf16 v[200:215], v[184:187], v[32:39], v15
    s_add_u32 m0, s62, 57344
    s_add_u32 s98, s62, 90112
    buffer_load_dwordx4 v3, s[40:43], s98 offen sc1 lds
    v_sub_f32 v42, v42, v4
    v_exp_f32 v42, v42
    v_sub_f32 v43, v43, v4
    v_exp_f32 v43, v43
    v_sub_f32 v44, v44, v4
    v_exp_f32 v44, v44
    v_sub_f32 v45, v45, v4
    v_exp_f32 v45, v45
    v_sub_f32 v46, v46, v4
    v_exp_f32 v46, v46
    v_sub_f32 v47, v47, v4
    v_exp_f32 v47, v47
    s_setprio 3
    v_sub_f32 v16, v16, v125
    v_exp_f32 v16, v16
    v_sub_f32 v17, v17, v125
    v_exp_f32 v17, v17
    v_sub_f32 v18, v18, v125
    v_exp_f32 v18, v18
    v_smfmac_f32_32x32x32_bf16 v[200:215], v[188:191], v[40:47], v15
    s_mov_b64 exec, s[60:61]
    ds_read_b128 v[184:187], v127 offset:13312
    ds_read_b128 v[188:191], v127 offset:13568
    s_mov_b64 exec, -1
    v_sub_f32 v19, v19, v125
    v_exp_f32 v19, v19
    v_sub_f32 v20, v20, v125
    v_exp_f32 v20, v20
    v_sub_f32 v21, v21, v125
    v_exp_f32 v21, v21
    v_mfma_f32_32x32x16_bf16 v[32:47], v[192:195], v[196:199], 0
    ds_read_b128 v[192:195], v127 offset:12288
    v_sub_f32 v22, v22, v125
    v_exp_f32 v22, v22
    v_sub_f32 v23, v23, v125
    v_exp_f32 v23, v23
    v_sub_f32 v24, v24, v125
    v_exp_f32 v24, v24
    v_sub_f32 v25, v25, v125
    v_exp_f32 v25, v25
    v_smfmac_f32_32x32x32_bf16 v[160:175], v[176:179], v[16:23], v15
    s_add_u32 m0, s62, 65536
    s_add_u32 s98, s62, 98304
    buffer_load_dwordx4 v3, s[40:43], s98 offen sc1 lds
    v_sub_f32 v26, v26, v125
    v_exp_f32 v26, v26
    v_sub_f32 v27, v27, v125
    v_exp_f32 v27, v27
    v_sub_f32 v28, v28, v125
    v_exp_f32 v28, v28
    v_sub_f32 v29, v29, v125
    v_exp_f32 v29, v29
    v_sub_f32 v30, v30, v125
    v_exp_f32 v30, v30
    v_sub_f32 v31, v31, v125
    v_exp_f32 v31, v31
    v_mov_b32 v12, s49
    v_mov_b32 v11, 0
    s_waitcnt vmcnt(5)
    s_mov_b64 exec, 1
    buffer_store_dword v12, v11, s[40:43], s58 offen sc1
    s_mov_b64 exec, -1
    s_setprio 2
    v_sub_f32 v32, v32, v4
    v_exp_f32 v32, v32
    v_sub_f32 v33, v33, v4
    v_exp_f32 v33, v33
    v_sub_f32 v34, v34, v4
    v_exp_f32 v34, v34
    v_smfmac_f32_32x32x32_bf16 v[160:175], v[180:183], v[24:31], v15
    v_sub_f32 v35, v35, v4
    v_exp_f32 v35, v35
    v_sub_f32 v36, v36, v4
    v_exp_f32 v36, v36
    v_sub_f32 v37, v37, v4
    v_exp_f32 v37, v37
    s_waitcnt lgkmcnt(0)
    v_mfma_f32_32x32x16_bf16 v[16:31], v[192:195], v[120:123], 0
    v_sub_f32 v38, v38, v4
    v_exp_f32 v38, v38
    v_sub_f32 v39, v39, v4
    v_exp_f32 v39, v39
    v_sub_f32 v40, v40, v4
    v_exp_f32 v40, v40
    v_sub_f32 v41, v41, v4
    v_exp_f32 v41, v41
    v_smfmac_f32_32x32x32_bf16 v[200:215], v[176:179], v[32:39], v15
    s_add_u32 m0, s62, 73728
    s_add_u32 s98, s62, 106496
    buffer_load_dwordx4 v3, s[40:43], s98 offen sc1 lds
    v_sub_f32 v42, v42, v4
    v_exp_f32 v42, v42
    v_sub_f32 v43, v43, v4
    v_exp_f32 v43, v43
    v_sub_f32 v44, v44, v4
    v_exp_f32 v44, v44
    v_sub_f32 v45, v45, v4
    v_exp_f32 v45, v45
    v_sub_f32 v46, v46, v4
    v_exp_f32 v46, v46
    v_sub_f32 v47, v47, v4
    v_exp_f32 v47, v47
    s_setprio 1
    v_sub_f32 v16, v16, v125
    v_exp_f32 v16, v16
    v_sub_f32 v17, v17, v125
    v_exp_f32 v17, v17
    v_sub_f32 v18, v18, v125
    v_exp_f32 v18, v18
    v_smfmac_f32_32x32x32_bf16 v[200:215], v[180:183], v[40:47], v15
    s_mov_b64 exec, s[60:61]
    ds_read_b128 v[176:179], v127 offset:17408
    ds_read_b128 v[180:183], v127 offset:17664
    s_mov_b64 exec, -1
    v_sub_f32 v19, v19, v125
    v_exp_f32 v19, v19
    v_sub_f32 v20, v20, v125
    v_exp_f32 v20, v20
    v_sub_f32 v21, v21, v125
    v_exp_f32 v21, v21
    v_mfma_f32_32x32x16_bf16 v[32:47], v[192:195], v[196:199], 0
    ds_read_b128 v[192:195], v127 offset:16384
    v_sub_f32 v22, v22, v125
    v_exp_f32 v22, v22
    v_sub_f32 v23, v23, v125
    v_exp_f32 v23, v23
    v_sub_f32 v24, v24, v125
    v_exp_f32 v24, v24
    v_sub_f32 v25, v25, v125
    v_exp_f32 v25, v25
    v_smfmac_f32_32x32x32_bf16 v[160:175], v[184:187], v[16:23], v15
    s_add_u32 m0, s62, 81920
    s_add_u32 s98, s62, 114688
    buffer_load_dwordx4 v3, s[40:43], s98 offen sc1 lds
    v_sub_f32 v26, v26, v125
    v_exp_f32 v26, v26
    v_sub_f32 v27, v27, v125
    v_exp_f32 v27, v27
    v_sub_f32 v28, v28, v125
    v_exp_f32 v28, v28
    v_sub_f32 v29, v29, v125
    v_exp_f32 v29, v29
    v_sub_f32 v30, v30, v125
    v_exp_f32 v30, v30
    v_sub_f32 v31, v31, v125
    v_exp_f32 v31, v31
    s_setprio 0
    v_sub_f32 v32, v32, v4
    v_exp_f32 v32, v32
    v_sub_f32 v33, v33, v4
    v_exp_f32 v33, v33
    v_sub_f32 v34, v34, v4
    v_exp_f32 v34, v34
    v_smfmac_f32_32x32x32_bf16 v[160:175], v[188:191], v[24:31], v15
    v_sub_f32 v35, v35, v4
    v_exp_f32 v35, v35
    v_sub_f32 v36, v36, v4
    v_exp_f32 v36, v36
    v_sub_f32 v37, v37, v4
    v_exp_f32 v37, v37
    s_waitcnt lgkmcnt(0)
    v_mfma_f32_32x32x16_bf16 v[16:31], v[192:195], v[120:123], 0
    v_sub_f32 v38, v38, v4
    v_exp_f32 v38, v38
    v_sub_f32 v39, v39, v4
    v_exp_f32 v39, v39
    v_sub_f32 v40, v40, v4
    v_exp_f32 v40, v40
    v_sub_f32 v41, v41, v4
    v_exp_f32 v41, v41
    v_smfmac_f32_32x32x32_bf16 v[200:215], v[184:187], v[32:39], v15
    s_add_u32 m0, s62, 90112
    s_add_u32 s98, s62, 122880
    buffer_load_dwordx4 v3, s[40:43], s98 offen sc1 lds
    v_sub_f32 v42, v42, v4
    v_exp_f32 v42, v42
    v_sub_f32 v43, v43, v4
    v_exp_f32 v43, v43
    v_sub_f32 v44, v44, v4
    v_exp_f32 v44, v44
    v_sub_f32 v45, v45, v4
    v_exp_f32 v45, v45
    v_sub_f32 v46, v46, v4
    v_exp_f32 v46, v46
    v_sub_f32 v47, v47, v4
    v_exp_f32 v47, v47
    s_setprio 3
    v_sub_f32 v16, v16, v125
    v_exp_f32 v16, v16
    v_sub_f32 v17, v17, v125
    v_exp_f32 v17, v17
    v_sub_f32 v18, v18, v125
    v_exp_f32 v18, v18
    v_smfmac_f32_32x32x32_bf16 v[200:215], v[188:191], v[40:47], v15
    s_mov_b64 exec, s[60:61]
    ds_read_b128 v[184:187], v127 offset:21504
    ds_read_b128 v[188:191], v127 offset:21760
    s_mov_b64 exec, -1
    v_sub_f32 v19, v19, v125
    v_exp_f32 v19, v19
    v_sub_f32 v20, v20, v125
    v_exp_f32 v20, v20
    v_sub_f32 v21, v21, v125
    v_exp_f32 v21, v21
    v_mfma_f32_32x32x16_bf16 v[32:47], v[192:195], v[196:199], 0
    ds_read_b128 v[192:195], v127 offset:20480
    v_sub_f32 v22, v22, v125
    v_exp_f32 v22, v22
    v_sub_f32 v23, v23, v125
    v_exp_f32 v23, v23
    v_sub_f32 v24, v24, v125
    v_exp_f32 v24, v24
    v_sub_f32 v25, v25, v125
    v_exp_f32 v25, v25
    v_smfmac_f32_32x32x32_bf16 v[160:175], v[176:179], v[16:23], v15
    v_sub_f32 v26, v26, v125
    v_exp_f32 v26, v26
    v_sub_f32 v27, v27, v125
    v_exp_f32 v27, v27
    v_sub_f32 v28, v28, v125
    v_exp_f32 v28, v28
    v_sub_f32 v29, v29, v125
    v_exp_f32 v29, v29
    v_sub_f32 v30, v30, v125
    v_exp_f32 v30, v30
    v_sub_f32 v31, v31, v125
    v_exp_f32 v31, v31
    s_setprio 2
    v_sub_f32 v32, v32, v4
    v_exp_f32 v32, v32
    v_sub_f32 v33, v33, v4
    v_exp_f32 v33, v33
    v_sub_f32 v34, v34, v4
    v_exp_f32 v34, v34
    v_smfmac_f32_32x32x32_bf16 v[160:175], v[180:183], v[24:31], v15
    v_sub_f32 v35, v35, v4
    v_exp_f32 v35, v35
    v_sub_f32 v36, v36, v4
    v_exp_f32 v36, v36
    v_sub_f32 v37, v37, v4
    v_exp_f32 v37, v37
    s_waitcnt lgkmcnt(0)
    v_mfma_f32_32x32x16_bf16 v[16:31], v[192:195], v[120:123], 0
    v_sub_f32 v38, v38, v4
    v_exp_f32 v38, v38
    v_sub_f32 v39, v39, v4
    v_exp_f32 v39, v39
    v_sub_f32 v40, v40, v4
    v_exp_f32 v40, v40
    v_sub_f32 v41, v41, v4
    v_exp_f32 v41, v41
    v_smfmac_f32_32x32x32_bf16 v[200:215], v[176:179], v[32:39], v15
    v_sub_f32 v42, v42, v4
    v_exp_f32 v42, v42
    v_sub_f32 v43, v43, v4
    v_exp_f32 v43, v43
    v_sub_f32 v44, v44, v4
    v_exp_f32 v44, v44
    v_sub_f32 v45, v45, v4
    v_exp_f32 v45, v45
    v_sub_f32 v46, v46, v4
    v_exp_f32 v46, v46
    v_sub_f32 v47, v47, v4
    v_exp_f32 v47, v47
    s_setprio 1
    v_sub_f32 v16, v16, v125
    v_exp_f32 v16, v16
    v_sub_f32 v17, v17, v125
    v_exp_f32 v17, v17
    v_sub_f32 v18, v18, v125
    v_exp_f32 v18, v18
    v_smfmac_f32_32x32x32_bf16 v[200:215], v[180:183], v[40:47], v15
    s_mov_b64 exec, s[60:61]
    ds_read_b128 v[176:179], v127 offset:25600
    ds_read_b128 v[180:183], v127 offset:25856
    s_mov_b64 exec, -1
    v_sub_f32 v19, v19, v125
    v_exp_f32 v19, v19
    v_sub_f32 v20, v20, v125
    v_exp_f32 v20, v20
    v_sub_f32 v21, v21, v125
    v_exp_f32 v21, v21
    v_mfma_f32_32x32x16_bf16 v[32:47], v[192:195], v[196:199], 0
    ds_read_b128 v[192:195], v127 offset:24576
    v_sub_f32 v22, v22, v125
    v_exp_f32 v22, v22
    v_sub_f32 v23, v23, v125
    v_exp_f32 v23, v23
    v_sub_f32 v24, v24, v125
    v_exp_f32 v24, v24
    v_sub_f32 v25, v25, v125
    v_exp_f32 v25, v25
    v_smfmac_f32_32x32x32_bf16 v[160:175], v[184:187], v[16:23], v15
    v_lshlrev_b32 v11, 10, v2
    s_and_b32 s99, s47, 3
    s_lshl_b32 s99, s99, 1
    s_and_b32 s100, s48, 1
    s_add_u32 s99, s99, s100
    s_lshr_b32 s100, s48, 1
    s_lshl_b32 s100, s100, 7
    s_mul_i32 s101, s99, 229376
    s_add_u32 s101, s101, s100
    s_mul_i32 s98, s44, 28672
    s_add_u32 s101, s101, s98
    s_bfm_b64 exec, 28, 0
    buffer_load_dword v129, v11, s[28:31], s101 offen
    s_mov_b64 exec, -1
    v_sub_f32 v26, v26, v125
    v_exp_f32 v26, v26
    v_sub_f32 v27, v27, v125
    v_exp_f32 v27, v27
    v_sub_f32 v28, v28, v125
    v_exp_f32 v28, v28
    v_sub_f32 v29, v29, v125
    v_exp_f32 v29, v29
    v_sub_f32 v30, v30, v125
    v_exp_f32 v30, v30
    v_sub_f32 v31, v31, v125
    v_exp_f32 v31, v31
    s_setprio 0
    v_sub_f32 v32, v32, v4
    v_exp_f32 v32, v32
    v_sub_f32 v33, v33, v4
    v_exp_f32 v33, v33
    v_sub_f32 v34, v34, v4
    v_exp_f32 v34, v34
    v_smfmac_f32_32x32x32_bf16 v[160:175], v[188:191], v[24:31], v15
    v_sub_f32 v35, v35, v4
    v_exp_f32 v35, v35
    v_sub_f32 v36, v36, v4
    v_exp_f32 v36, v36
    v_sub_f32 v37, v37, v4
    v_exp_f32 v37, v37
    s_waitcnt lgkmcnt(0)
    v_mfma_f32_32x32x16_bf16 v[16:31], v[192:195], v[120:123], 0
    v_sub_f32 v38, v38, v4
    v_exp_f32 v38, v38
    v_sub_f32 v39, v39, v4
    v_exp_f32 v39, v39
    v_sub_f32 v40, v40, v4
    v_exp_f32 v40, v40
    v_sub_f32 v41, v41, v4
    v_exp_f32 v41, v41
    v_smfmac_f32_32x32x32_bf16 v[200:215], v[184:187], v[32:39], v15
    s_mul_i32 s101, s99, 65536
    s_add_u32 s101, s101, s100
    s_mul_i32 s98, s44, 8192
    s_add_u32 s101, s101, s98
    s_bfm_b64 exec, 8, 0
    buffer_load_dword v128, v11, s[16:19], s101 offen
    s_mov_b64 exec, -1
    v_sub_f32 v42, v42, v4
    v_exp_f32 v42, v42
    v_sub_f32 v43, v43, v4
    v_exp_f32 v43, v43
    v_sub_f32 v44, v44, v4
    v_exp_f32 v44, v44
    v_sub_f32 v45, v45, v4
    v_exp_f32 v45, v45
    v_sub_f32 v46, v46, v4
    v_exp_f32 v46, v46
    v_sub_f32 v47, v47, v4
    v_exp_f32 v47, v47
    s_setprio 3
    v_sub_f32 v16, v16, v125
    v_exp_f32 v16, v16
    v_sub_f32 v17, v17, v125
    v_exp_f32 v17, v17
    v_sub_f32 v18, v18, v125
    v_exp_f32 v18, v18
    v_smfmac_f32_32x32x32_bf16 v[200:215], v[188:191], v[40:47], v15
    s_mov_b64 exec, s[60:61]
    ds_read_b128 v[184:187], v127 offset:29696
    ds_read_b128 v[188:191], v127 offset:29952
    s_mov_b64 exec, -1
    v_sub_f32 v19, v19, v125
    v_exp_f32 v19, v19
    v_sub_f32 v20, v20, v125
    v_exp_f32 v20, v20
    v_sub_f32 v21, v21, v125
    v_exp_f32 v21, v21
    v_mfma_f32_32x32x16_bf16 v[32:47], v[192:195], v[196:199], 0
    ds_read_b128 v[192:195], v127 offset:28672
    v_sub_f32 v22, v22, v125
    v_exp_f32 v22, v22
    v_sub_f32 v23, v23, v125
    v_exp_f32 v23, v23
    v_sub_f32 v24, v24, v125
    v_exp_f32 v24, v24
    v_sub_f32 v25, v25, v125
    v_exp_f32 v25, v25
    v_smfmac_f32_32x32x32_bf16 v[160:175], v[176:179], v[16:23], v15
    v_sub_f32 v26, v26, v125
    v_exp_f32 v26, v26
    v_sub_f32 v27, v27, v125
    v_exp_f32 v27, v27
    v_sub_f32 v28, v28, v125
    v_exp_f32 v28, v28
    v_sub_f32 v29, v29, v125
    v_exp_f32 v29, v29
    v_sub_f32 v30, v30, v125
    v_exp_f32 v30, v30
    v_sub_f32 v31, v31, v125
    v_exp_f32 v31, v31
    s_setprio 2
    v_sub_f32 v32, v32, v4
    v_exp_f32 v32, v32
    v_sub_f32 v33, v33, v4
    v_exp_f32 v33, v33
    v_sub_f32 v34, v34, v4
    v_exp_f32 v34, v34
    v_smfmac_f32_32x32x32_bf16 v[160:175], v[180:183], v[24:31], v15
    v_sub_f32 v35, v35, v4
    v_exp_f32 v35, v35
    v_sub_f32 v36, v36, v4
    v_exp_f32 v36, v36
    v_sub_f32 v37, v37, v4
    v_exp_f32 v37, v37
    s_waitcnt lgkmcnt(0)
    v_mfma_f32_32x32x16_bf16 v[16:31], v[192:195], v[120:123], 0
    v_sub_f32 v38, v38, v4
    v_exp_f32 v38, v38
    v_sub_f32 v39, v39, v4
    v_exp_f32 v39, v39
    v_sub_f32 v40, v40, v4
    v_exp_f32 v40, v40
    v_sub_f32 v41, v41, v4
    v_exp_f32 v41, v41
    v_smfmac_f32_32x32x32_bf16 v[200:215], v[176:179], v[32:39], v15
    v_sub_f32 v42, v42, v4
    v_exp_f32 v42, v42
    v_sub_f32 v43, v43, v4
    v_exp_f32 v43, v43
    v_sub_f32 v44, v44, v4
    v_exp_f32 v44, v44
    v_sub_f32 v45, v45, v4
    v_exp_f32 v45, v45
    v_sub_f32 v46, v46, v4
    v_exp_f32 v46, v46
    v_sub_f32 v47, v47, v4
    v_exp_f32 v47, v47
    s_waitcnt vmcnt(2)
    s_barrier
    s_setprio 1
    v_sub_f32 v16, v16, v125
    v_exp_f32 v16, v16
    v_sub_f32 v17, v17, v125
    v_exp_f32 v17, v17
    v_sub_f32 v18, v18, v125
    v_exp_f32 v18, v18
    v_smfmac_f32_32x32x32_bf16 v[200:215], v[180:183], v[40:47], v15
    s_mov_b64 exec, s[60:61]
    ds_read_b128 v[176:179], v0 offset:1024
    ds_read_b128 v[180:183], v0 offset:1280
    s_mov_b64 exec, -1
    v_sub_f32 v19, v19, v125
    v_exp_f32 v19, v19
    v_sub_f32 v20, v20, v125
    v_exp_f32 v20, v20
    v_sub_f32 v21, v21, v125
    v_exp_f32 v21, v21
    v_mfma_f32_32x32x16_bf16 v[32:47], v[192:195], v[196:199], 0
    ds_read_b128 v[192:195], v0 offset:0
    v_sub_f32 v22, v22, v125
    v_exp_f32 v22, v22
    v_sub_f32 v23, v23, v125
    v_exp_f32 v23, v23
    v_sub_f32 v24, v24, v125
    v_exp_f32 v24, v24
    v_sub_f32 v25, v25, v125
    v_exp_f32 v25, v25
    v_smfmac_f32_32x32x32_bf16 v[160:175], v[184:187], v[16:23], v15
    s_add_u32 m0, s62, 98304
    s_add_u32 s98, s55, 0
    buffer_load_dwordx4 v6, s[28:31], s98 offen lds
    v_sub_f32 v26, v26, v125
    v_exp_f32 v26, v26
    v_sub_f32 v27, v27, v125
    v_exp_f32 v27, v27
    v_sub_f32 v28, v28, v125
    v_exp_f32 v28, v28
    v_sub_f32 v29, v29, v125
    v_exp_f32 v29, v29
    v_sub_f32 v30, v30, v125
    v_exp_f32 v30, v30
    v_sub_f32 v31, v31, v125
    v_exp_f32 v31, v31
    s_setprio 0
    v_sub_f32 v32, v32, v4
    v_exp_f32 v32, v32
    v_sub_f32 v33, v33, v4
    v_exp_f32 v33, v33
    v_sub_f32 v34, v34, v4
    v_exp_f32 v34, v34
    v_smfmac_f32_32x32x32_bf16 v[160:175], v[188:191], v[24:31], v15
    v_sub_f32 v35, v35, v4
    v_exp_f32 v35, v35
    v_sub_f32 v36, v36, v4
    v_exp_f32 v36, v36
    v_sub_f32 v37, v37, v4
    v_exp_f32 v37, v37
    s_waitcnt lgkmcnt(0)
    v_mfma_f32_32x32x16_bf16 v[16:31], v[192:195], v[120:123], 0
    v_sub_f32 v38, v38, v4
    v_exp_f32 v38, v38
    v_sub_f32 v39, v39, v4
    v_exp_f32 v39, v39
    v_sub_f32 v40, v40, v4
    v_exp_f32 v40, v40
    v_sub_f32 v41, v41, v4
    v_exp_f32 v41, v41
    v_smfmac_f32_32x32x32_bf16 v[200:215], v[184:187], v[32:39], v15
    s_add_u32 m0, s62, 106496
    s_add_u32 s98, s55, 65536
    buffer_load_dwordx4 v6, s[28:31], s98 offen lds
    v_sub_f32 v42, v42, v4
    v_exp_f32 v42, v42
    v_sub_f32 v43, v43, v4
    v_exp_f32 v43, v43
    v_sub_f32 v44, v44, v4
    v_exp_f32 v44, v44
    v_sub_f32 v45, v45, v4
    v_exp_f32 v45, v45
    v_sub_f32 v46, v46, v4
    v_exp_f32 v46, v46
    v_sub_f32 v47, v47, v4
    v_exp_f32 v47, v47
    s_setprio 3
    v_sub_f32 v16, v16, v125
    v_exp_f32 v16, v16
    v_sub_f32 v17, v17, v125
    v_exp_f32 v17, v17
    v_sub_f32 v18, v18, v125
    v_exp_f32 v18, v18
    v_smfmac_f32_32x32x32_bf16 v[200:215], v[188:191], v[40:47], v15
    s_mov_b64 exec, s[60:61]
    ds_read_b128 v[184:187], v0 offset:5120
    ds_read_b128 v[188:191], v0 offset:5376
    s_mov_b64 exec, -1
    v_sub_f32 v19, v19, v125
    v_exp_f32 v19, v19
    v_sub_f32 v20, v20, v125
    v_exp_f32 v20, v20
    v_sub_f32 v21, v21, v125
    v_exp_f32 v21, v21
    v_mfma_f32_32x32x16_bf16 v[32:47], v[192:195], v[196:199], 0
    ds_read_b128 v[192:195], v0 offset:4096
    v_sub_f32 v22, v22, v125
    v_exp_f32 v22, v22
    v_sub_f32 v23, v23, v125
    v_exp_f32 v23, v23
    v_sub_f32 v24, v24, v125
    v_exp_f32 v24, v24
    v_sub_f32 v25, v25, v125
    v_exp_f32 v25, v25
    v_smfmac_f32_32x32x32_bf16 v[160:175], v[176:179], v[16:23], v15
    s_add_u32 m0, s62, 114688
    s_add_u32 s98, s55, 131072
    buffer_load_dwordx4 v6, s[28:31], s98 offen lds
    v_sub_f32 v26, v26, v125
    v_exp_f32 v26, v26
    v_sub_f32 v27, v27, v125
    v_exp_f32 v27, v27
    v_sub_f32 v28, v28, v125
    v_exp_f32 v28, v28
    v_sub_f32 v29, v29, v125
    v_exp_f32 v29, v29
    v_sub_f32 v30, v30, v125
    v_exp_f32 v30, v30
    v_sub_f32 v31, v31, v125
    v_exp_f32 v31, v31
    s_setprio 2
    v_sub_f32 v32, v32, v4
    v_exp_f32 v32, v32
    v_sub_f32 v33, v33, v4
    v_exp_f32 v33, v33
    v_sub_f32 v34, v34, v4
    v_exp_f32 v34, v34
    v_smfmac_f32_32x32x32_bf16 v[160:175], v[180:183], v[24:31], v15
    v_sub_f32 v35, v35, v4
    v_exp_f32 v35, v35
    v_sub_f32 v36, v36, v4
    v_exp_f32 v36, v36
    v_sub_f32 v37, v37, v4
    v_exp_f32 v37, v37
    s_waitcnt lgkmcnt(0)
    v_mfma_f32_32x32x16_bf16 v[16:31], v[192:195], v[120:123], 0
    v_sub_f32 v38, v38, v4
    v_exp_f32 v38, v38
    v_sub_f32 v39, v39, v4
    v_exp_f32 v39, v39
    v_sub_f32 v40, v40, v4
    v_exp_f32 v40, v40
    v_sub_f32 v41, v41, v4
    v_exp_f32 v41, v41
    v_smfmac_f32_32x32x32_bf16 v[200:215], v[176:179], v[32:39], v15
    s_add_u32 m0, s62, 122880
    s_add_u32 s98, s55, 196608
    buffer_load_dwordx4 v6, s[28:31], s98 offen lds
    v_sub_f32 v42, v42, v4
    v_exp_f32 v42, v42
    v_sub_f32 v43, v43, v4
    v_exp_f32 v43, v43
    v_sub_f32 v44, v44, v4
    v_exp_f32 v44, v44
    v_sub_f32 v45, v45, v4
    v_exp_f32 v45, v45
    v_sub_f32 v46, v46, v4
    v_exp_f32 v46, v46
    v_sub_f32 v47, v47, v4
    v_exp_f32 v47, v47
    s_setprio 1
    v_sub_f32 v16, v16, v125
    v_exp_f32 v16, v16
    v_sub_f32 v17, v17, v125
    v_exp_f32 v17, v17
    v_sub_f32 v18, v18, v125
    v_exp_f32 v18, v18
    v_smfmac_f32_32x32x32_bf16 v[200:215], v[180:183], v[40:47], v15
    s_mov_b64 exec, s[60:61]
    ds_read_b128 v[176:179], v0 offset:9216
    ds_read_b128 v[180:183], v0 offset:9472
    s_mov_b64 exec, -1
    v_sub_f32 v19, v19, v125
    v_exp_f32 v19, v19
    v_sub_f32 v20, v20, v125
    v_exp_f32 v20, v20
    v_sub_f32 v21, v21, v125
    v_exp_f32 v21, v21
    v_mfma_f32_32x32x16_bf16 v[32:47], v[192:195], v[196:199], 0
    ds_read_b128 v[192:195], v0 offset:8192
    v_sub_f32 v22, v22, v125
    v_exp_f32 v22, v22
    v_sub_f32 v23, v23, v125
    v_exp_f32 v23, v23
    v_sub_f32 v24, v24, v125
    v_exp_f32 v24, v24
    v_sub_f32 v25, v25, v125
    v_exp_f32 v25, v25
    v_smfmac_f32_32x32x32_bf16 v[160:175], v[184:187], v[16:23], v15
    s_add_u32 m0, s62, 131072
    s_add_u32 s98, s55, 262144
    buffer_load_dwordx4 v6, s[28:31], s98 offen lds
    v_sub_f32 v26, v26, v125
    v_exp_f32 v26, v26
    v_sub_f32 v27, v27, v125
    v_exp_f32 v27, v27
    v_sub_f32 v28, v28, v125
    v_exp_f32 v28, v28
    v_sub_f32 v29, v29, v125
    v_exp_f32 v29, v29
    v_sub_f32 v30, v30, v125
    v_exp_f32 v30, v30
    v_sub_f32 v31, v31, v125
    v_exp_f32 v31, v31
    s_setprio 0
    v_sub_f32 v32, v32, v4
    v_exp_f32 v32, v32
    v_sub_f32 v33, v33, v4
    v_exp_f32 v33, v33
    v_sub_f32 v34, v34, v4
    v_exp_f32 v34, v34
    v_smfmac_f32_32x32x32_bf16 v[160:175], v[188:191], v[24:31], v15
    v_sub_f32 v35, v35, v4
    v_exp_f32 v35, v35
    v_sub_f32 v36, v36, v4
    v_exp_f32 v36, v36
    v_sub_f32 v37, v37, v4
    v_exp_f32 v37, v37
    s_waitcnt lgkmcnt(0)
    v_mfma_f32_32x32x16_bf16 v[16:31], v[192:195], v[120:123], 0
    v_sub_f32 v38, v38, v4
    v_exp_f32 v38, v38
    v_sub_f32 v39, v39, v4
    v_exp_f32 v39, v39
    v_sub_f32 v40, v40, v4
    v_exp_f32 v40, v40
    v_sub_f32 v41, v41, v4
    v_exp_f32 v41, v41
    v_smfmac_f32_32x32x32_bf16 v[200:215], v[184:187], v[32:39], v15
    s_add_u32 m0, s62, 139264
    s_add_u32 s98, s55, 327680
    buffer_load_dwordx4 v6, s[28:31], s98 offen lds
    v_sub_f32 v42, v42, v4
    v_exp_f32 v42, v42
    v_sub_f32 v43, v43, v4
    v_exp_f32 v43, v43
    v_sub_f32 v44, v44, v4
    v_exp_f32 v44, v44
    v_sub_f32 v45, v45, v4
    v_exp_f32 v45, v45
    v_sub_f32 v46, v46, v4
    v_exp_f32 v46, v46
    v_sub_f32 v47, v47, v4
    v_exp_f32 v47, v47
    s_setprio 3
    v_sub_f32 v16, v16, v125
    v_exp_f32 v16, v16
    v_sub_f32 v17, v17, v125
    v_exp_f32 v17, v17
    v_sub_f32 v18, v18, v125
    v_exp_f32 v18, v18
    v_smfmac_f32_32x32x32_bf16 v[200:215], v[188:191], v[40:47], v15
    s_mov_b64 exec, s[60:61]
    ds_read_b128 v[184:187], v0 offset:13312
    ds_read_b128 v[188:191], v0 offset:13568
    s_mov_b64 exec, -1
    v_sub_f32 v19, v19, v125
    v_exp_f32 v19, v19
    v_sub_f32 v20, v20, v125
    v_exp_f32 v20, v20
    v_sub_f32 v21, v21, v125
    v_exp_f32 v21, v21
    v_mfma_f32_32x32x16_bf16 v[32:47], v[192:195], v[196:199], 0
    ds_read_b128 v[192:195], v0 offset:12288
    v_sub_f32 v22, v22, v125
    v_exp_f32 v22, v22
    v_sub_f32 v23, v23, v125
    v_exp_f32 v23, v23
    v_sub_f32 v24, v24, v125
    v_exp_f32 v24, v24
    v_sub_f32 v25, v25, v125
    v_exp_f32 v25, v25
    v_smfmac_f32_32x32x32_bf16 v[160:175], v[176:179], v[16:23], v15
    s_add_u32 m0, s62, 147456
    s_add_u32 s98, s55, 393216
    buffer_load_dwordx4 v6, s[28:31], s98 offen lds
    v_sub_f32 v26, v26, v125
    v_exp_f32 v26, v26
    v_sub_f32 v27, v27, v125
    v_exp_f32 v27, v27
    v_sub_f32 v28, v28, v125
    v_exp_f32 v28, v28
    v_sub_f32 v29, v29, v125
    v_exp_f32 v29, v29
    v_sub_f32 v30, v30, v125
    v_exp_f32 v30, v30
    v_sub_f32 v31, v31, v125
    v_exp_f32 v31, v31
    s_setprio 2
    v_sub_f32 v32, v32, v4
    v_exp_f32 v32, v32
    v_sub_f32 v33, v33, v4
    v_exp_f32 v33, v33
    v_sub_f32 v34, v34, v4
    v_exp_f32 v34, v34
    v_smfmac_f32_32x32x32_bf16 v[160:175], v[180:183], v[24:31], v15
    v_sub_f32 v35, v35, v4
    v_exp_f32 v35, v35
    v_sub_f32 v36, v36, v4
    v_exp_f32 v36, v36
    v_sub_f32 v37, v37, v4
    v_exp_f32 v37, v37
    s_waitcnt lgkmcnt(0)
    v_mfma_f32_32x32x16_bf16 v[16:31], v[192:195], v[120:123], 0
    v_sub_f32 v38, v38, v4
    v_exp_f32 v38, v38
    v_sub_f32 v39, v39, v4
    v_exp_f32 v39, v39
    v_sub_f32 v40, v40, v4
    v_exp_f32 v40, v40
    v_sub_f32 v41, v41, v4
    v_exp_f32 v41, v41
    v_smfmac_f32_32x32x32_bf16 v[200:215], v[176:179], v[32:39], v15
    s_add_u32 m0, s62, 155648
    s_add_u32 s98, s55, 458752
    buffer_load_dwordx4 v6, s[28:31], s98 offen lds
    v_sub_f32 v42, v42, v4
    v_exp_f32 v42, v42
    v_sub_f32 v43, v43, v4
    v_exp_f32 v43, v43
    v_sub_f32 v44, v44, v4
    v_exp_f32 v44, v44
    v_sub_f32 v45, v45, v4
    v_exp_f32 v45, v45
    v_sub_f32 v46, v46, v4
    v_exp_f32 v46, v46
    v_sub_f32 v47, v47, v4
    v_exp_f32 v47, v47
    s_setprio 1
    v_sub_f32 v16, v16, v125
    v_exp_f32 v16, v16
    v_sub_f32 v17, v17, v125
    v_exp_f32 v17, v17
    v_sub_f32 v18, v18, v125
    v_exp_f32 v18, v18
    v_smfmac_f32_32x32x32_bf16 v[200:215], v[180:183], v[40:47], v15
    s_mov_b64 exec, s[60:61]
    ds_read_b128 v[176:179], v0 offset:17408
    ds_read_b128 v[180:183], v0 offset:17664
    s_mov_b64 exec, -1
    v_sub_f32 v19, v19, v125
    v_exp_f32 v19, v19
    v_sub_f32 v20, v20, v125
    v_exp_f32 v20, v20
    v_sub_f32 v21, v21, v125
    v_exp_f32 v21, v21
    v_mfma_f32_32x32x16_bf16 v[32:47], v[192:195], v[196:199], 0
    ds_read_b128 v[192:195], v0 offset:16384
    v_sub_f32 v22, v22, v125
    v_exp_f32 v22, v22
    v_sub_f32 v23, v23, v125
    v_exp_f32 v23, v23
    v_sub_f32 v24, v24, v125
    v_exp_f32 v24, v24
    v_sub_f32 v25, v25, v125
    v_exp_f32 v25, v25
    v_smfmac_f32_32x32x32_bf16 v[160:175], v[184:187], v[16:23], v15
    v_and_b32 v11, 31, v2
    v_lshlrev_b32 v13, 6, v2
    s_lshr_b32 s66, s69, 1
    s_lshl_b32 s66, s66, 12
    s_add_u32 s66, s66, 327680
    buffer_load_dword v12, v13, s[40:43], s66 offen sc1
    v_sub_f32 v26, v26, v125
    v_exp_f32 v26, v26
    v_sub_f32 v27, v27, v125
    v_exp_f32 v27, v27
    v_sub_f32 v28, v28, v125
    v_exp_f32 v28, v28
    v_sub_f32 v29, v29, v125
    v_exp_f32 v29, v29
    v_sub_f32 v30, v30, v125
    v_exp_f32 v30, v30
    v_sub_f32 v31, v31, v125
    v_exp_f32 v31, v31
    s_setprio 0
    v_sub_f32 v32, v32, v4
    v_exp_f32 v32, v32
    v_sub_f32 v33, v33, v4
    v_exp_f32 v33, v33
    v_sub_f32 v34, v34, v4
    v_exp_f32 v34, v34
    v_smfmac_f32_32x32x32_bf16 v[160:175], v[188:191], v[24:31], v15
    v_sub_f32 v35, v35, v4
    v_exp_f32 v35, v35
    v_sub_f32 v36, v36, v4
    v_exp_f32 v36, v36
    v_sub_f32 v37, v37, v4
    v_exp_f32 v37, v37
    s_waitcnt lgkmcnt(0)
    v_mfma_f32_32x32x16_bf16 v[16:31], v[192:195], v[120:123], 0
    v_sub_f32 v38, v38, v4
    v_exp_f32 v38, v38
    v_sub_f32 v39, v39, v4
    v_exp_f32 v39, v39
    v_sub_f32 v40, v40, v4
    v_exp_f32 v40, v40
    v_sub_f32 v41, v41, v4
    v_exp_f32 v41, v41
    v_smfmac_f32_32x32x32_bf16 v[200:215], v[184:187], v[32:39], v15
    v_sub_f32 v42, v42, v4
    v_exp_f32 v42, v42
    v_sub_f32 v43, v43, v4
    v_exp_f32 v43, v43
    v_sub_f32 v44, v44, v4
    v_exp_f32 v44, v44
    v_sub_f32 v45, v45, v4
    v_exp_f32 v45, v45
    v_sub_f32 v46, v46, v4
    v_exp_f32 v46, v46
    v_sub_f32 v47, v47, v4
    v_exp_f32 v47, v47
    s_setprio 3
    v_sub_f32 v16, v16, v125
    v_exp_f32 v16, v16
    v_sub_f32 v17, v17, v125
    v_exp_f32 v17, v17
    v_sub_f32 v18, v18, v125
    v_exp_f32 v18, v18
    v_smfmac_f32_32x32x32_bf16 v[200:215], v[188:191], v[40:47], v15
    s_mov_b64 exec, s[60:61]
    ds_read_b128 v[184:187], v0 offset:21504
    ds_read_b128 v[188:191], v0 offset:21760
    s_mov_b64 exec, -1
    v_sub_f32 v19, v19, v125
    v_exp_f32 v19, v19
    v_sub_f32 v20, v20, v125
    v_exp_f32 v20, v20
    v_sub_f32 v21, v21, v125
    v_exp_f32 v21, v21
    v_mfma_f32_32x32x16_bf16 v[32:47], v[192:195], v[196:199], 0
    ds_read_b128 v[192:195], v0 offset:20480
    v_sub_f32 v22, v22, v125
    v_exp_f32 v22, v22
    v_sub_f32 v23, v23, v125
    v_exp_f32 v23, v23
    v_sub_f32 v24, v24, v125
    v_exp_f32 v24, v24
    v_sub_f32 v25, v25, v125
    v_exp_f32 v25, v25
    v_smfmac_f32_32x32x32_bf16 v[160:175], v[176:179], v[16:23], v15
    v_sub_f32 v26, v26, v125
    v_exp_f32 v26, v26
    v_sub_f32 v27, v27, v125
    v_exp_f32 v27, v27
    v_sub_f32 v28, v28, v125
    v_exp_f32 v28, v28
    v_sub_f32 v29, v29, v125
    v_exp_f32 v29, v29
    v_sub_f32 v30, v30, v125
    v_exp_f32 v30, v30
    v_sub_f32 v31, v31, v125
    v_exp_f32 v31, v31
    s_waitcnt vmcnt(0)
    v_cmp_ne_u32 vcc, s49, v12
    s_nop 0
    s_cbranch_vccnz L_hp_s
L_hp_s_r:
    s_setprio 2
    v_sub_f32 v32, v32, v4
    v_exp_f32 v32, v32
    v_sub_f32 v33, v33, v4
    v_exp_f32 v33, v33
    v_sub_f32 v34, v34, v4
    v_exp_f32 v34, v34
    v_smfmac_f32_32x32x32_bf16 v[160:175], v[180:183], v[24:31], v15
    v_sub_f32 v35, v35, v4
    v_exp_f32 v35, v35
    v_sub_f32 v36, v36, v4
    v_exp_f32 v36, v36
    v_sub_f32 v37, v37, v4
    v_exp_f32 v37, v37
    s_waitcnt lgkmcnt(0)
    v_mfma_f32_32x32x16_bf16 v[16:31], v[192:195], v[120:123], 0
    v_sub_f32 v38, v38, v4
    v_exp_f32 v38, v38
    v_sub_f32 v39, v39, v4
    v_exp_f32 v39, v39
    v_sub_f32 v40, v40, v4
    v_exp_f32 v40, v40
    v_sub_f32 v41, v41, v4
    v_exp_f32 v41, v41
    v_smfmac_f32_32x32x32_bf16 v[200:215], v[176:179], v[32:39], v15
    v_lshlrev_b32 v11, 2, v11
    s_lshl_b32 s99, s69, 7
    s_add_u32 s99, s99, 131072
    buffer_load_dword v126, v11, s[40:43], s99 offen sc1
    s_lshl_b32 s99, s47, 9
    s_lshl_b32 s100, s46, 7
    s_add_u32 s99, s99, s100
    s_add_u32 s99, s99, 131072
    buffer_load_dword v124, v11, s[40:43], s99 offen sc1
    s_lshr_b32 s100, s44, 1
    s_lshl_b32 s66, s100, 12
    s_add_u32 s66, s66, s68
    v_sub_f32 v42, v42, v4
    v_exp_f32 v42, v42
    v_sub_f32 v43, v43, v4
    v_exp_f32 v43, v43
    v_sub_f32 v44, v44, v4
    v_exp_f32 v44, v44
    v_sub_f32 v45, v45, v4
    v_exp_f32 v45, v45
    v_sub_f32 v46, v46, v4
    v_exp_f32 v46, v46
    v_sub_f32 v47, v47, v4
    v_exp_f32 v47, v47
    s_setprio 1
    v_sub_f32 v16, v16, v125
    v_exp_f32 v16, v16
    v_sub_f32 v17, v17, v125
    v_exp_f32 v17, v17
    v_sub_f32 v18, v18, v125
    v_exp_f32 v18, v18
    v_smfmac_f32_32x32x32_bf16 v[200:215], v[180:183], v[40:47], v15
    s_mov_b64 exec, s[60:61]
    ds_read_b128 v[176:179], v0 offset:25600
    ds_read_b128 v[180:183], v0 offset:25856
    s_mov_b64 exec, -1
    v_sub_f32 v19, v19, v125
    v_exp_f32 v19, v19
    v_sub_f32 v20, v20, v125
    v_exp_f32 v20, v20
    v_sub_f32 v21, v21, v125
    v_exp_f32 v21, v21
    v_mfma_f32_32x32x16_bf16 v[32:47], v[192:195], v[196:199], 0
    ds_read_b128 v[192:195], v0 offset:24576
    v_sub_f32 v22, v22, v125
    v_exp_f32 v22, v22
    v_sub_f32 v23, v23, v125
    v_exp_f32 v23, v23
    v_sub_f32 v24, v24, v125
    v_exp_f32 v24, v24
    v_sub_f32 v25, v25, v125
    v_exp_f32 v25, v25
    v_smfmac_f32_32x32x32_bf16 v[160:175], v[184:187], v[16:23], v15
    buffer_load_dwordx4 v[48:51], v3, s[40:43], s66 offen offset:0 sc1
    v_sub_f32 v26, v26, v125
    v_exp_f32 v26, v26
    v_sub_f32 v27, v27, v125
    v_exp_f32 v27, v27
    v_sub_f32 v28, v28, v125
    v_exp_f32 v28, v28
    v_sub_f32 v29, v29, v125
    v_exp_f32 v29, v29
    v_sub_f32 v30, v30, v125
    v_exp_f32 v30, v30
    v_sub_f32 v31, v31, v125
    v_exp_f32 v31, v31
    s_setprio 0
    v_sub_f32 v32, v32, v4
    v_exp_f32 v32, v32
    v_sub_f32 v33, v33, v4
    v_exp_f32 v33, v33
    v_sub_f32 v34, v34, v4
    v_exp_f32 v34, v34
    v_smfmac_f32_32x32x32_bf16 v[160:175], v[188:191], v[24:31], v15
    v_sub_f32 v35, v35, v4
    v_exp_f32 v35, v35
    v_sub_f32 v36, v36, v4
    v_exp_f32 v36, v36
    v_sub_f32 v37, v37, v4
    v_exp_f32 v37, v37
    s_waitcnt lgkmcnt(0)
    v_mfma_f32_32x32x16_bf16 v[16:31], v[192:195], v[120:123], 0
    v_sub_f32 v38, v38, v4
    v_exp_f32 v38, v38
    v_sub_f32 v39, v39, v4
    v_exp_f32 v39, v39
    v_sub_f32 v40, v40, v4
    v_exp_f32 v40, v40
    v_sub_f32 v41, v41, v4
    v_exp_f32 v41, v41
    v_smfmac_f32_32x32x32_bf16 v[200:215], v[184:187], v[32:39], v15
    buffer_load_dwordx4 v[52:55], v3, s[40:43], s66 offen offset:1024 sc1
    v_sub_f32 v42, v42, v4
    v_exp_f32 v42, v42
    v_sub_f32 v43, v43, v4
    v_exp_f32 v43, v43
    v_sub_f32 v44, v44, v4
    v_exp_f32 v44, v44
    v_sub_f32 v45, v45, v4
    v_exp_f32 v45, v45
    v_sub_f32 v46, v46, v4
    v_exp_f32 v46, v46
    v_sub_f32 v47, v47, v4
    v_exp_f32 v47, v47
    s_setprio 3
    v_sub_f32 v16, v16, v125
    v_exp_f32 v16, v16
    v_sub_f32 v17, v17, v125
    v_exp_f32 v17, v17
    v_sub_f32 v18, v18, v125
    v_exp_f32 v18, v18
    v_smfmac_f32_32x32x32_bf16 v[200:215], v[188:191], v[40:47], v15
    s_mov_b64 exec, s[60:61]
    ds_read_b128 v[184:187], v0 offset:29696
    ds_read_b128 v[188:191], v0 offset:29952
    s_mov_b64 exec, -1
    v_sub_f32 v19, v19, v125
    v_exp_f32 v19, v19
    v_sub_f32 v20, v20, v125
    v_exp_f32 v20, v20
    v_sub_f32 v21, v21, v125
    v_exp_f32 v21, v21
    v_mfma_f32_32x32x16_bf16 v[32:47], v[192:195], v[196:199], 0
    ds_read_b128 v[192:195], v0 offset:28672
    v_sub_f32 v22, v22, v125
    v_exp_f32 v22, v22
    v_sub_f32 v23, v23, v125
    v_exp_f32 v23, v23
    v_sub_f32 v24, v24, v125
    v_exp_f32 v24, v24
    v_sub_f32 v25, v25, v125
    v_exp_f32 v25, v25
    v_smfmac_f32_32x32x32_bf16 v[160:175], v[176:179], v[16:23], v15
    buffer_load_dwordx4 v[56:59], v3, s[40:43], s66 offen offset:2048 sc1
    v_sub_f32 v26, v26, v125
    v_exp_f32 v26, v26
    v_sub_f32 v27, v27, v125
    v_exp_f32 v27, v27
    v_sub_f32 v28, v28, v125
    v_exp_f32 v28, v28
    v_sub_f32 v29, v29, v125
    v_exp_f32 v29, v29
    v_sub_f32 v30, v30, v125
    v_exp_f32 v30, v30
    v_sub_f32 v31, v31, v125
    v_exp_f32 v31, v31
    s_setprio 2
    v_sub_f32 v32, v32, v4
    v_exp_f32 v32, v32
    v_sub_f32 v33, v33, v4
    v_exp_f32 v33, v33
    v_sub_f32 v34, v34, v4
    v_exp_f32 v34, v34
    v_smfmac_f32_32x32x32_bf16 v[160:175], v[180:183], v[24:31], v15
    v_sub_f32 v35, v35, v4
    v_exp_f32 v35, v35
    v_sub_f32 v36, v36, v4
    v_exp_f32 v36, v36
    v_sub_f32 v37, v37, v4
    v_exp_f32 v37, v37
    s_waitcnt lgkmcnt(0)
    v_mfma_f32_32x32x16_bf16 v[16:31], v[192:195], v[120:123], 0
    v_sub_f32 v38, v38, v4
    v_exp_f32 v38, v38
    v_sub_f32 v39, v39, v4
    v_exp_f32 v39, v39
    v_sub_f32 v40, v40, v4
    v_exp_f32 v40, v40
    v_sub_f32 v41, v41, v4
    v_exp_f32 v41, v41
    v_smfmac_f32_32x32x32_bf16 v[200:215], v[176:179], v[32:39], v15
    buffer_load_dwordx4 v[60:63], v3, s[40:43], s66 offen offset:3072 sc1
    v_sub_f32 v42, v42, v4
    v_exp_f32 v42, v42
    v_sub_f32 v43, v43, v4
    v_exp_f32 v43, v43
    v_sub_f32 v44, v44, v4
    v_exp_f32 v44, v44
    v_sub_f32 v45, v45, v4
    v_exp_f32 v45, v45
    v_sub_f32 v46, v46, v4
    v_exp_f32 v46, v46
    v_sub_f32 v47, v47, v4
    v_exp_f32 v47, v47
    s_setprio 1
    v_sub_f32 v16, v16, v125
    v_exp_f32 v16, v16
    v_sub_f32 v17, v17, v125
    v_exp_f32 v17, v17
    v_sub_f32 v18, v18, v125
    v_exp_f32 v18, v18
    v_smfmac_f32_32x32x32_bf16 v[200:215], v[180:183], v[40:47], v15
    s_mov_b64 exec, s[60:61]
    ds_read_b128 v[176:179], v0 offset:33792
    ds_read_b128 v[180:183], v0 offset:34048
    s_mov_b64 exec, -1
    v_sub_f32 v19, v19, v125
    v_exp_f32 v19, v19
    v_sub_f32 v20, v20, v125
    v_exp_f32 v20, v20
    v_sub_f32 v21, v21, v125
    v_exp_f32 v21, v21
    v_mfma_f32_32x32x16_bf16 v[32:47], v[192:195], v[196:199], 0
    ds_read_b128 v[192:195], v0 offset:32768
    v_sub_f32 v22, v22, v125
    v_exp_f32 v22, v22
    v_sub_f32 v23, v23, v125
    v_exp_f32 v23, v23
    v_sub_f32 v24, v24, v125
    v_exp_f32 v24, v24
    v_sub_f32 v25, v25, v125
    v_exp_f32 v25, v25
    v_smfmac_f32_32x32x32_bf16 v[160:175], v[184:187], v[16:23], v15
    s_add_u32 s66, s66, 16384
    buffer_load_dwordx4 v[64:67], v3, s[40:43], s66 offen offset:0 sc1
    v_sub_f32 v26, v26, v125
    v_exp_f32 v26, v26
    v_sub_f32 v27, v27, v125
    v_exp_f32 v27, v27
    v_sub_f32 v28, v28, v125
    v_exp_f32 v28, v28
    v_sub_f32 v29, v29, v125
    v_exp_f32 v29, v29
    v_sub_f32 v30, v30, v125
    v_exp_f32 v30, v30
    v_sub_f32 v31, v31, v125
    v_exp_f32 v31, v31
    s_setprio 0
    v_sub_f32 v32, v32, v4
    v_exp_f32 v32, v32
    v_sub_f32 v33, v33, v4
    v_exp_f32 v33, v33
    v_sub_f32 v34, v34, v4
    v_exp_f32 v34, v34
    v_smfmac_f32_32x32x32_bf16 v[160:175], v[188:191], v[24:31], v15
    v_sub_f32 v35, v35, v4
    v_exp_f32 v35, v35
    v_sub_f32 v36, v36, v4
    v_exp_f32 v36, v36
    v_sub_f32 v37, v37, v4
    v_exp_f32 v37, v37
    s_waitcnt lgkmcnt(0)
    v_mfma_f32_32x32x16_bf16 v[16:31], v[192:195], v[120:123], 0
    v_sub_f32 v38, v38, v4
    v_exp_f32 v38, v38
    v_sub_f32 v39, v39, v4
    v_exp_f32 v39, v39
    v_sub_f32 v40, v40, v4
    v_exp_f32 v40, v40
    v_sub_f32 v41, v41, v4
    v_exp_f32 v41, v41
    v_smfmac_f32_32x32x32_bf16 v[200:215], v[184:187], v[32:39], v15
    buffer_load_dwordx4 v[68:71], v3, s[40:43], s66 offen offset:1024 sc1
    v_sub_f32 v42, v42, v4
    v_exp_f32 v42, v42
    v_sub_f32 v43, v43, v4
    v_exp_f32 v43, v43
    v_sub_f32 v44, v44, v4
    v_exp_f32 v44, v44
    v_sub_f32 v45, v45, v4
    v_exp_f32 v45, v45
    v_sub_f32 v46, v46, v4
    v_exp_f32 v46, v46
    v_sub_f32 v47, v47, v4
    v_exp_f32 v47, v47
    s_setprio 3
    v_sub_f32 v16, v16, v125
    v_exp_f32 v16, v16
    v_sub_f32 v17, v17, v125
    v_exp_f32 v17, v17
    v_sub_f32 v18, v18, v125
    v_exp_f32 v18, v18
    v_smfmac_f32_32x32x32_bf16 v[200:215], v[188:191], v[40:47], v15
    s_mov_b64 exec, s[60:61]
    ds_read_b128 v[184:187], v0 offset:37888
    ds_read_b128 v[188:191], v0 offset:38144
    s_mov_b64 exec, -1
    v_sub_f32 v19, v19, v125
    v_exp_f32 v19, v19
    v_sub_f32 v20, v20, v125
    v_exp_f32 v20, v20
    v_sub_f32 v21, v21, v125
    v_exp_f32 v21, v21
    v_mfma_f32_32x32x16_bf16 v[32:47], v[192:195], v[196:199], 0
    ds_read_b128 v[192:195], v0 offset:36864
    v_sub_f32 v22, v22, v125
    v_exp_f32 v22, v22
    v_sub_f32 v23, v23, v125
    v_exp_f32 v23, v23
    v_sub_f32 v24, v24, v125
    v_exp_f32 v24, v24
    v_sub_f32 v25, v25, v125
    v_exp_f32 v25, v25
    v_smfmac_f32_32x32x32_bf16 v[160:175], v[176:179], v[16:23], v15
    buffer_load_dwordx4 v[72:75], v3, s[40:43], s66 offen offset:2048 sc1
    v_sub_f32 v26, v26, v125
    v_exp_f32 v26, v26
    v_sub_f32 v27, v27, v125
    v_exp_f32 v27, v27
    v_sub_f32 v28, v28, v125
    v_exp_f32 v28, v28
    v_sub_f32 v29, v29, v125
    v_exp_f32 v29, v29
    v_sub_f32 v30, v30, v125
    v_exp_f32 v30, v30
    v_sub_f32 v31, v31, v125
    v_exp_f32 v31, v31
    s_setprio 2
    v_sub_f32 v32, v32, v4
    v_exp_f32 v32, v32
    v_sub_f32 v33, v33, v4
    v_exp_f32 v33, v33
    v_sub_f32 v34, v34, v4
    v_exp_f32 v34, v34
    v_smfmac_f32_32x32x32_bf16 v[160:175], v[180:183], v[24:31], v15
    v_sub_f32 v35, v35, v4
    v_exp_f32 v35, v35
    v_sub_f32 v36, v36, v4
    v_exp_f32 v36, v36
    v_sub_f32 v37, v37, v4
    v_exp_f32 v37, v37
    s_waitcnt lgkmcnt(0)
    v_mfma_f32_32x32x16_bf16 v[16:31], v[192:195], v[120:123], 0
    v_sub_f32 v38, v38, v4
    v_exp_f32 v38, v38
    v_sub_f32 v39, v39, v4
    v_exp_f32 v39, v39
    v_sub_f32 v40, v40, v4
    v_exp_f32 v40, v40
    v_sub_f32 v41, v41, v4
    v_exp_f32 v41, v41
    v_smfmac_f32_32x32x32_bf16 v[200:215], v[176:179], v[32:39], v15
    buffer_load_dwordx4 v[76:79], v3, s[40:43], s66 offen offset:3072 sc1
    v_sub_f32 v42, v42, v4
    v_exp_f32 v42, v42
    v_sub_f32 v43, v43, v4
    v_exp_f32 v43, v43
    v_sub_f32 v44, v44, v4
    v_exp_f32 v44, v44
    v_sub_f32 v45, v45, v4
    v_exp_f32 v45, v45
    v_sub_f32 v46, v46, v4
    v_exp_f32 v46, v46
    v_sub_f32 v47, v47, v4
    v_exp_f32 v47, v47
    s_waitcnt vmcnt(8)
    s_mov_b32 s101, 1069066811
    v_mul_f32 v126, s101, v126
    v_mul_f32 v124, s101, v124
    v_exp_f32 v126, v126
    v_exp_f32 v124, -v124
    v_add_f32 v126, 1.0, v126
    v_add_f32 v124, 1.0, v124
    v_rcp_f32 v126, v126
    v_rcp_f32 v124, v124
    v_add_u32 v8, 98304, v5
    v_xor_b32 v9, 64, v8
    s_setprio 1
    v_sub_f32 v16, v16, v125
    v_exp_f32 v16, v16
    v_sub_f32 v17, v17, v125
    v_exp_f32 v17, v17
    v_sub_f32 v18, v18, v125
    v_exp_f32 v18, v18
    v_smfmac_f32_32x32x32_bf16 v[200:215], v[180:183], v[40:47], v15
    s_mov_b64 exec, s[60:61]
    ds_read_b128 v[176:179], v0 offset:41984
    ds_read_b128 v[180:183], v0 offset:42240
    s_mov_b64 exec, -1
    v_sub_f32 v19, v19, v125
    v_exp_f32 v19, v19
    v_sub_f32 v20, v20, v125
    v_exp_f32 v20, v20
    v_sub_f32 v21, v21, v125
    v_exp_f32 v21, v21
    v_mfma_f32_32x32x16_bf16 v[32:47], v[192:195], v[196:199], 0
    ds_read_b128 v[192:195], v0 offset:40960
    v_sub_f32 v22, v22, v125
    v_exp_f32 v22, v22
    v_sub_f32 v23, v23, v125
    v_exp_f32 v23, v23
    v_sub_f32 v24, v24, v125
    v_exp_f32 v24, v24
    v_sub_f32 v25, v25, v125
    v_exp_f32 v25, v25
    v_smfmac_f32_32x32x32_bf16 v[160:175], v[184:187], v[16:23], v15
    s_add_u32 s66, s66, 16384
    buffer_load_dwordx4 v[80:83], v3, s[40:43], s66 offen offset:0 sc1
    v_sub_f32 v26, v26, v125
    v_exp_f32 v26, v26
    v_sub_f32 v27, v27, v125
    v_exp_f32 v27, v27
    v_sub_f32 v28, v28, v125
    v_exp_f32 v28, v28
    v_sub_f32 v29, v29, v125
    v_exp_f32 v29, v29
    v_sub_f32 v30, v30, v125
    v_exp_f32 v30, v30
    v_sub_f32 v31, v31, v125
    v_exp_f32 v31, v31
    s_setprio 0
    v_sub_f32 v32, v32, v4
    v_exp_f32 v32, v32
    v_sub_f32 v33, v33, v4
    v_exp_f32 v33, v33
    v_sub_f32 v34, v34, v4
    v_exp_f32 v34, v34
    v_smfmac_f32_32x32x32_bf16 v[160:175], v[188:191], v[24:31], v15
    v_sub_f32 v35, v35, v4
    v_exp_f32 v35, v35
    v_sub_f32 v36, v36, v4
    v_exp_f32 v36, v36
    v_sub_f32 v37, v37, v4
    v_exp_f32 v37, v37
    s_waitcnt lgkmcnt(0)
    v_mfma_f32_32x32x16_bf16 v[16:31], v[192:195], v[120:123], 0
    v_sub_f32 v38, v38, v4
    v_exp_f32 v38, v38
    v_sub_f32 v39, v39, v4
    v_exp_f32 v39, v39
    v_sub_f32 v40, v40, v4
    v_exp_f32 v40, v40
    v_sub_f32 v41, v41, v4
    v_exp_f32 v41, v41
    v_smfmac_f32_32x32x32_bf16 v[200:215], v[184:187], v[32:39], v15
    buffer_load_dwordx4 v[84:87], v3, s[40:43], s66 offen offset:1024 sc1
    v_sub_f32 v42, v42, v4
    v_exp_f32 v42, v42
    v_sub_f32 v43, v43, v4
    v_exp_f32 v43, v43
    v_sub_f32 v44, v44, v4
    v_exp_f32 v44, v44
    v_sub_f32 v45, v45, v4
    v_exp_f32 v45, v45
    v_sub_f32 v46, v46, v4
    v_exp_f32 v46, v46
    v_sub_f32 v47, v47, v4
    v_exp_f32 v47, v47
    s_setprio 3
    v_sub_f32 v16, v16, v125
    v_exp_f32 v16, v16
    v_sub_f32 v17, v17, v125
    v_exp_f32 v17, v17
    v_sub_f32 v18, v18, v125
    v_exp_f32 v18, v18
    v_smfmac_f32_32x32x32_bf16 v[200:215], v[188:191], v[40:47], v15
    s_mov_b64 exec, s[60:61]
    ds_read_b128 v[184:187], v0 offset:46080
    ds_read_b128 v[188:191], v0 offset:46336
    s_mov_b64 exec, -1
    v_sub_f32 v19, v19, v125
    v_exp_f32 v19, v19
    v_sub_f32 v20, v20, v125
    v_exp_f32 v20, v20
    v_sub_f32 v21, v21, v125
    v_exp_f32 v21, v21
    v_mfma_f32_32x32x16_bf16 v[32:47], v[192:195], v[196:199], 0
    ds_read_b128 v[192:195], v0 offset:45056
    v_sub_f32 v22, v22, v125
    v_exp_f32 v22, v22
    v_sub_f32 v23, v23, v125
    v_exp_f32 v23, v23
    v_sub_f32 v24, v24, v125
    v_exp_f32 v24, v24
    v_sub_f32 v25, v25, v125
    v_exp_f32 v25, v25
    v_smfmac_f32_32x32x32_bf16 v[160:175], v[176:179], v[16:23], v15
    buffer_load_dwordx4 v[88:91], v3, s[40:43], s66 offen offset:2048 sc1
    v_sub_f32 v26, v26, v125
    v_exp_f32 v26, v26
    v_sub_f32 v27, v27, v125
    v_exp_f32 v27, v27
    v_sub_f32 v28, v28, v125
    v_exp_f32 v28, v28
    v_sub_f32 v29, v29, v125
    v_exp_f32 v29, v29
    v_sub_f32 v30, v30, v125
    v_exp_f32 v30, v30
    v_sub_f32 v31, v31, v125
    v_exp_f32 v31, v31
    s_setprio 2
    v_sub_f32 v32, v32, v4
    v_exp_f32 v32, v32
    v_sub_f32 v33, v33, v4
    v_exp_f32 v33, v33
    v_sub_f32 v34, v34, v4
    v_exp_f32 v34, v34
    v_smfmac_f32_32x32x32_bf16 v[160:175], v[180:183], v[24:31], v15
    v_sub_f32 v35, v35, v4
    v_exp_f32 v35, v35
    v_sub_f32 v36, v36, v4
    v_exp_f32 v36, v36
    v_sub_f32 v37, v37, v4
    v_exp_f32 v37, v37
    s_waitcnt lgkmcnt(0)
    v_mfma_f32_32x32x16_bf16 v[16:31], v[192:195], v[120:123], 0
    v_sub_f32 v38, v38, v4
    v_exp_f32 v38, v38
    v_sub_f32 v39, v39, v4
    v_exp_f32 v39, v39
    v_sub_f32 v40, v40, v4
    v_exp_f32 v40, v40
    v_sub_f32 v41, v41, v4
    v_exp_f32 v41, v41
    v_smfmac_f32_32x32x32_bf16 v[200:215], v[176:179], v[32:39], v15
    buffer_load_dwordx4 v[92:95], v3, s[40:43], s66 offen offset:3072 sc1
    v_sub_f32 v42, v42, v4
    v_exp_f32 v42, v42
    v_sub_f32 v43, v43, v4
    v_exp_f32 v43, v43
    v_sub_f32 v44, v44, v4
    v_exp_f32 v44, v44
    v_sub_f32 v45, v45, v4
    v_exp_f32 v45, v45
    v_sub_f32 v46, v46, v4
    v_exp_f32 v46, v46
    v_sub_f32 v47, v47, v4
    v_exp_f32 v47, v47
    s_setprio 1
    v_sub_f32 v16, v16, v125
    v_exp_f32 v16, v16
    v_sub_f32 v17, v17, v125
    v_exp_f32 v17, v17
    v_sub_f32 v18, v18, v125
    v_exp_f32 v18, v18
    v_smfmac_f32_32x32x32_bf16 v[200:215], v[180:183], v[40:47], v15
    s_mov_b64 exec, s[60:61]
    ds_read_b128 v[176:179], v0 offset:50176
    ds_read_b128 v[180:183], v0 offset:50432
    s_mov_b64 exec, -1
    v_sub_f32 v19, v19, v125
    v_exp_f32 v19, v19
    v_sub_f32 v20, v20, v125
    v_exp_f32 v20, v20
    v_sub_f32 v21, v21, v125
    v_exp_f32 v21, v21
    v_mfma_f32_32x32x16_bf16 v[32:47], v[192:195], v[196:199], 0
    ds_read_b128 v[192:195], v0 offset:49152
    v_sub_f32 v22, v22, v125
    v_exp_f32 v22, v22
    v_sub_f32 v23, v23, v125
    v_exp_f32 v23, v23
    v_sub_f32 v24, v24, v125
    v_exp_f32 v24, v24
    v_sub_f32 v25, v25, v125
    v_exp_f32 v25, v25
    v_smfmac_f32_32x32x32_bf16 v[160:175], v[184:187], v[16:23], v15
    s_add_u32 s66, s66, 16384
    buffer_load_dwordx4 v[96:99], v3, s[40:43], s66 offen offset:0 sc1
    v_sub_f32 v26, v26, v125
    v_exp_f32 v26, v26
    v_sub_f32 v27, v27, v125
    v_exp_f32 v27, v27
    v_sub_f32 v28, v28, v125
    v_exp_f32 v28, v28
    v_sub_f32 v29, v29, v125
    v_exp_f32 v29, v29
    v_sub_f32 v30, v30, v125
    v_exp_f32 v30, v30
    v_sub_f32 v31, v31, v125
    v_exp_f32 v31, v31
    s_setprio 0
    v_sub_f32 v32, v32, v4
    v_exp_f32 v32, v32
    v_sub_f32 v33, v33, v4
    v_exp_f32 v33, v33
    v_sub_f32 v34, v34, v4
    v_exp_f32 v34, v34
    v_smfmac_f32_32x32x32_bf16 v[160:175], v[188:191], v[24:31], v15
    v_sub_f32 v35, v35, v4
    v_exp_f32 v35, v35
    v_sub_f32 v36, v36, v4
    v_exp_f32 v36, v36
    v_sub_f32 v37, v37, v4
    v_exp_f32 v37, v37
    s_waitcnt lgkmcnt(0)
    v_mfma_f32_32x32x16_bf16 v[16:31], v[192:195], v[120:123], 0
    v_sub_f32 v38, v38, v4
    v_exp_f32 v38, v38
    v_sub_f32 v39, v39, v4
    v_exp_f32 v39, v39
    v_sub_f32 v40, v40, v4
    v_exp_f32 v40, v40
    v_sub_f32 v41, v41, v4
    v_exp_f32 v41, v41
    v_smfmac_f32_32x32x32_bf16 v[200:215], v[184:187], v[32:39], v15
    buffer_load_dwordx4 v[100:103], v3, s[40:43], s66 offen offset:1024 sc1
    v_sub_f32 v42, v42, v4
    v_exp_f32 v42, v42
    v_sub_f32 v43, v43, v4
    v_exp_f32 v43, v43
    v_sub_f32 v44, v44, v4
    v_exp_f32 v44, v44
    v_sub_f32 v45, v45, v4
    v_exp_f32 v45, v45
    v_sub_f32 v46, v46, v4
    v_exp_f32 v46, v46
    v_sub_f32 v47, v47, v4
    v_exp_f32 v47, v47
    s_setprio 3
    v_sub_f32 v16, v16, v125
    v_exp_f32 v16, v16
    v_sub_f32 v17, v17, v125
    v_exp_f32 v17, v17
    v_sub_f32 v18, v18, v125
    v_exp_f32 v18, v18
    v_smfmac_f32_32x32x32_bf16 v[200:215], v[188:191], v[40:47], v15
    s_mov_b64 exec, s[60:61]
    ds_read_b128 v[184:187], v0 offset:54272
    ds_read_b128 v[188:191], v0 offset:54528
    s_mov_b64 exec, -1
    v_sub_f32 v19, v19, v125
    v_exp_f32 v19, v19
    v_sub_f32 v20, v20, v125
    v_exp_f32 v20, v20
    v_sub_f32 v21, v21, v125
    v_exp_f32 v21, v21
    v_mfma_f32_32x32x16_bf16 v[32:47], v[192:195], v[196:199], 0
    ds_read_b128 v[192:195], v0 offset:53248
    v_sub_f32 v22, v22, v125
    v_exp_f32 v22, v22
    v_sub_f32 v23, v23, v125
    v_exp_f32 v23, v23
    v_sub_f32 v24, v24, v125
    v_exp_f32 v24, v24
    v_sub_f32 v25, v25, v125
    v_exp_f32 v25, v25
    v_smfmac_f32_32x32x32_bf16 v[160:175], v[176:179], v[16:23], v15
    buffer_load_dwordx4 v[104:107], v3, s[40:43], s66 offen offset:2048 sc1
    v_sub_f32 v26, v26, v125
    v_exp_f32 v26, v26
    v_sub_f32 v27, v27, v125
    v_exp_f32 v27, v27
    v_sub_f32 v28, v28, v125
    v_exp_f32 v28, v28
    v_sub_f32 v29, v29, v125
    v_exp_f32 v29, v29
    v_sub_f32 v30, v30, v125
    v_exp_f32 v30, v30
    v_sub_f32 v31, v31, v125
    v_exp_f32 v31, v31
    s_setprio 2
    v_sub_f32 v32, v32, v4
    v_exp_f32 v32, v32
    v_sub_f32 v33, v33, v4
    v_exp_f32 v33, v33
    v_sub_f32 v34, v34, v4
    v_exp_f32 v34, v34
    v_smfmac_f32_32x32x32_bf16 v[160:175], v[180:183], v[24:31], v15
    v_sub_f32 v35, v35, v4
    v_exp_f32 v35, v35
    v_sub_f32 v36, v36, v4
    v_exp_f32 v36, v36
    v_sub_f32 v37, v37, v4
    v_exp_f32 v37, v37
    s_waitcnt lgkmcnt(0)
    v_mfma_f32_32x32x16_bf16 v[16:31], v[192:195], v[120:123], 0
    v_sub_f32 v38, v38, v4
    v_exp_f32 v38, v38
    v_sub_f32 v39, v39, v4
    v_exp_f32 v39, v39
    v_sub_f32 v40, v40, v4
    v_exp_f32 v40, v40
    v_sub_f32 v41, v41, v4
    v_exp_f32 v41, v41
    v_smfmac_f32_32x32x32_bf16 v[200:215], v[176:179], v[32:39], v15
    buffer_load_dwordx4 v[108:111], v3, s[40:43], s66 offen offset:3072 sc1
    v_sub_f32 v42, v42, v4
    v_exp_f32 v42, v42
    v_sub_f32 v43, v43, v4
    v_exp_f32 v43, v43
    v_sub_f32 v44, v44, v4
    v_exp_f32 v44, v44
    v_sub_f32 v45, v45, v4
    v_exp_f32 v45, v45
    v_sub_f32 v46, v46, v4
    v_exp_f32 v46, v46
    v_sub_f32 v47, v47, v4
    v_exp_f32 v47, v47
    s_setprio 1
    v_sub_f32 v16, v16, v125
    v_exp_f32 v16, v16
    v_sub_f32 v17, v17, v125
    v_exp_f32 v17, v17
    v_sub_f32 v18, v18, v125
    v_exp_f32 v18, v18
    v_smfmac_f32_32x32x32_bf16 v[200:215], v[180:183], v[40:47], v15
    s_mov_b64 exec, s[60:61]
    ds_read_b128 v[176:179], v0 offset:58368
    ds_read_b128 v[180:183], v0 offset:58624
    s_mov_b64 exec, -1
    v_sub_f32 v19, v19, v125
    v_exp_f32 v19, v19
    v_sub_f32 v20, v20, v125
    v_exp_f32 v20, v20
    v_sub_f32 v21, v21, v125
    v_exp_f32 v21, v21
    v_mfma_f32_32x32x16_bf16 v[32:47], v[192:195], v[196:199], 0
    ds_read_b128 v[192:195], v0 offset:57344
    v_sub_f32 v22, v22, v125
    v_exp_f32 v22, v22
    v_sub_f32 v23, v23, v125
    v_exp_f32 v23, v23
    v_sub_f32 v24, v24, v125
    v_exp_f32 v24, v24
    v_sub_f32 v25, v25, v125
    v_exp_f32 v25, v25
    v_smfmac_f32_32x32x32_bf16 v[160:175], v[184:187], v[16:23], v15
    s_add_u32 s66, s66, 16384
    buffer_load_dwordx4 v[112:115], v3, s[40:43], s66 offen offset:0 sc1
    v_sub_f32 v26, v26, v125
    v_exp_f32 v26, v26
    v_sub_f32 v27, v27, v125
    v_exp_f32 v27, v27
    v_sub_f32 v28, v28, v125
    v_exp_f32 v28, v28
    v_sub_f32 v29, v29, v125
    v_exp_f32 v29, v29
    v_sub_f32 v30, v30, v125
    v_exp_f32 v30, v30
    v_sub_f32 v31, v31, v125
    v_exp_f32 v31, v31
    s_setprio 0
    v_sub_f32 v32, v32, v4
    v_exp_f32 v32, v32
    v_sub_f32 v33, v33, v4
    v_exp_f32 v33, v33
    v_sub_f32 v34, v34, v4
    v_exp_f32 v34, v34
    v_smfmac_f32_32x32x32_bf16 v[160:175], v[188:191], v[24:31], v15
    v_sub_f32 v35, v35, v4
    v_exp_f32 v35, v35
    v_sub_f32 v36, v36, v4
    v_exp_f32 v36, v36
    v_sub_f32 v37, v37, v4
    v_exp_f32 v37, v37
    s_waitcnt lgkmcnt(0)
    v_mfma_f32_32x32x16_bf16 v[16:31], v[192:195], v[120:123], 0
    v_sub_f32 v38, v38, v4
    v_exp_f32 v38, v38
    v_sub_f32 v39, v39, v4
    v_exp_f32 v39, v39
    v_sub_f32 v40, v40, v4
    v_exp_f32 v40, v40
    v_sub_f32 v41, v41, v4
    v_exp_f32 v41, v41
    v_smfmac_f32_32x32x32_bf16 v[200:215], v[184:187], v[32:39], v15
    buffer_load_dwordx4 v[116:119], v3, s[40:43], s66 offen offset:1024 sc1
    v_sub_f32 v42, v42, v4
    v_exp_f32 v42, v42
    v_sub_f32 v43, v43, v4
    v_exp_f32 v43, v43
    v_sub_f32 v44, v44, v4
    v_exp_f32 v44, v44
    v_sub_f32 v45, v45, v4
    v_exp_f32 v45, v45
    v_sub_f32 v46, v46, v4
    v_exp_f32 v46, v46
    v_sub_f32 v47, v47, v4
    v_exp_f32 v47, v47
    s_setprio 3
    v_sub_f32 v16, v16, v125
    v_exp_f32 v16, v16
    v_sub_f32 v17, v17, v125
    v_exp_f32 v17, v17
    v_sub_f32 v18, v18, v125
    v_exp_f32 v18, v18
    v_smfmac_f32_32x32x32_bf16 v[200:215], v[188:191], v[40:47], v15
    s_mov_b64 exec, s[60:61]
    ds_read_b128 v[184:187], v0 offset:62464
    ds_read_b128 v[188:191], v0 offset:62720
    s_mov_b64 exec, -1
    v_sub_f32 v19, v19, v125
    v_exp_f32 v19, v19
    v_sub_f32 v20, v20, v125
    v_exp_f32 v20, v20
    v_sub_f32 v21, v21, v125
    v_exp_f32 v21, v21
    v_mfma_f32_32x32x16_bf16 v[32:47], v[192:195], v[196:199], 0
    ds_read_b128 v[192:195], v0 offset:61440
    v_sub_f32 v22, v22, v125
    v_exp_f32 v22, v22
    v_sub_f32 v23, v23, v125
    v_exp_f32 v23, v23
    v_sub_f32 v24, v24, v125
    v_exp_f32 v24, v24
    v_sub_f32 v25, v25, v125
    v_exp_f32 v25, v25
    v_smfmac_f32_32x32x32_bf16 v[160:175], v[176:179], v[16:23], v15
    buffer_load_dwordx4 v[216:219], v3, s[40:43], s66 offen offset:2048 sc1
    v_sub_f32 v26, v26, v125
    v_exp_f32 v26, v26
    v_sub_f32 v27, v27, v125
    v_exp_f32 v27, v27
    v_sub_f32 v28, v28, v125
    v_exp_f32 v28, v28
    v_sub_f32 v29, v29, v125
    v_exp_f32 v29, v29
    v_sub_f32 v30, v30, v125
    v_exp_f32 v30, v30
    v_sub_f32 v31, v31, v125
    v_exp_f32 v31, v31
    s_setprio 2
    v_sub_f32 v32, v32, v4
    v_exp_f32 v32, v32
    v_sub_f32 v33, v33, v4
    v_exp_f32 v33, v33
    v_sub_f32 v34, v34, v4
    v_exp_f32 v34, v34
    v_smfmac_f32_32x32x32_bf16 v[160:175], v[180:183], v[24:31], v15
    v_sub_f32 v35, v35, v4
    v_exp_f32 v35, v35
    v_sub_f32 v36, v36, v4
    v_exp_f32 v36, v36
    v_sub_f32 v37, v37, v4
    v_exp_f32 v37, v37
    s_waitcnt lgkmcnt(0)
    v_mfma_f32_32x32x16_bf16 v[16:31], v[192:195], v[120:123], 0
    v_sub_f32 v38, v38, v4
    v_exp_f32 v38, v38
    v_sub_f32 v39, v39, v4
    v_exp_f32 v39, v39
    v_sub_f32 v40, v40, v4
    v_exp_f32 v40, v40
    v_sub_f32 v41, v41, v4
    v_exp_f32 v41, v41
    v_smfmac_f32_32x32x32_bf16 v[200:215], v[176:179], v[32:39], v15
    buffer_load_dwordx4 v[220:223], v3, s[40:43], s66 offen offset:3072 sc1
    v_sub_f32 v42, v42, v4
    v_exp_f32 v42, v42
    v_sub_f32 v43, v43, v4
    v_exp_f32 v43, v43
    v_sub_f32 v44, v44, v4
    v_exp_f32 v44, v44
    v_sub_f32 v45, v45, v4
    v_exp_f32 v45, v45
    v_sub_f32 v46, v46, v4
    v_exp_f32 v46, v46
    v_sub_f32 v47, v47, v4
    v_exp_f32 v47, v47
    s_setprio 1
    v_sub_f32 v16, v16, v125
    v_exp_f32 v16, v16
    v_sub_f32 v17, v17, v125
    v_exp_f32 v17, v17
    v_sub_f32 v18, v18, v125
    v_exp_f32 v18, v18
    v_smfmac_f32_32x32x32_bf16 v[200:215], v[180:183], v[40:47], v15
    s_mov_b64 exec, s[60:61]
    ds_read_b128 v[176:179], v1 offset:1024
    ds_read_b128 v[180:183], v1 offset:1280
    s_mov_b64 exec, -1
    v_sub_f32 v19, v19, v125
    v_exp_f32 v19, v19
    v_sub_f32 v20, v20, v125
    v_exp_f32 v20, v20
    v_sub_f32 v21, v21, v125
    v_exp_f32 v21, v21
    v_mfma_f32_32x32x16_bf16 v[32:47], v[192:195], v[196:199], 0
    ds_read_b128 v[192:195], v1 offset:0
    v_sub_f32 v22, v22, v125
    v_exp_f32 v22, v22
    v_sub_f32 v23, v23, v125
    v_exp_f32 v23, v23
    v_sub_f32 v24, v24, v125
    v_exp_f32 v24, v24
    v_sub_f32 v25, v25, v125
    v_exp_f32 v25, v25
    v_smfmac_f32_32x32x32_bf16 v[160:175], v[184:187], v[16:23], v15
    s_add_u32 s66, s66, 16384
    buffer_load_dwordx4 v[224:227], v3, s[40:43], s66 offen offset:0 sc1
    v_sub_f32 v26, v26, v125
    v_exp_f32 v26, v26
    v_sub_f32 v27, v27, v125
    v_exp_f32 v27, v27
    v_sub_f32 v28, v28, v125
    v_exp_f32 v28, v28
    v_sub_f32 v29, v29, v125
    v_exp_f32 v29, v29
    v_sub_f32 v30, v30, v125
    v_exp_f32 v30, v30
    v_sub_f32 v31, v31, v125
    v_exp_f32 v31, v31
    s_setprio 0
    v_sub_f32 v32, v32, v4
    v_exp_f32 v32, v32
    v_sub_f32 v33, v33, v4
    v_exp_f32 v33, v33
    v_sub_f32 v34, v34, v4
    v_exp_f32 v34, v34
    v_smfmac_f32_32x32x32_bf16 v[160:175], v[188:191], v[24:31], v15
    v_sub_f32 v35, v35, v4
    v_exp_f32 v35, v35
    v_sub_f32 v36, v36, v4
    v_exp_f32 v36, v36
    v_sub_f32 v37, v37, v4
    v_exp_f32 v37, v37
    s_waitcnt lgkmcnt(0)
    v_mfma_f32_32x32x16_bf16 v[16:31], v[192:195], v[120:123], 0
    v_sub_f32 v38, v38, v4
    v_exp_f32 v38, v38
    v_sub_f32 v39, v39, v4
    v_exp_f32 v39, v39
    v_sub_f32 v40, v40, v4
    v_exp_f32 v40, v40
    v_sub_f32 v41, v41, v4
    v_exp_f32 v41, v41
    v_smfmac_f32_32x32x32_bf16 v[200:215], v[184:187], v[32:39], v15
    buffer_load_dwordx4 v[228:231], v3, s[40:43], s66 offen offset:1024 sc1
    v_sub_f32 v42, v42, v4
    v_exp_f32 v42, v42
    v_sub_f32 v43, v43, v4
    v_exp_f32 v43, v43
    v_sub_f32 v44, v44, v4
    v_exp_f32 v44, v44
    v_sub_f32 v45, v45, v4
    v_exp_f32 v45, v45
    v_sub_f32 v46, v46, v4
    v_exp_f32 v46, v46
    v_sub_f32 v47, v47, v4
    v_exp_f32 v47, v47
    s_setprio 3
    v_sub_f32 v16, v16, v125
    v_exp_f32 v16, v16
    v_sub_f32 v17, v17, v125
    v_exp_f32 v17, v17
    v_sub_f32 v18, v18, v125
    v_exp_f32 v18, v18
    v_smfmac_f32_32x32x32_bf16 v[200:215], v[188:191], v[40:47], v15
    s_mov_b64 exec, s[60:61]
    ds_read_b128 v[184:187], v1 offset:5120
    ds_read_b128 v[188:191], v1 offset:5376
    s_mov_b64 exec, -1
    v_sub_f32 v19, v19, v125
    v_exp_f32 v19, v19
    v_sub_f32 v20, v20, v125
    v_exp_f32 v20, v20
    v_sub_f32 v21, v21, v125
    v_exp_f32 v21, v21
    v_mfma_f32_32x32x16_bf16 v[32:47], v[192:195], v[196:199], 0
    ds_read_b128 v[192:195], v1 offset:4096
    v_sub_f32 v22, v22, v125
    v_exp_f32 v22, v22
    v_sub_f32 v23, v23, v125
    v_exp_f32 v23, v23
    v_sub_f32 v24, v24, v125
    v_exp_f32 v24, v24
    v_sub_f32 v25, v25, v125
    v_exp_f32 v25, v25
    v_smfmac_f32_32x32x32_bf16 v[160:175], v[176:179], v[16:23], v15
    buffer_load_dwordx4 v[232:235], v3, s[40:43], s66 offen offset:2048 sc1
    v_sub_f32 v26, v26, v125
    v_exp_f32 v26, v26
    v_sub_f32 v27, v27, v125
    v_exp_f32 v27, v27
    v_sub_f32 v28, v28, v125
    v_exp_f32 v28, v28
    v_sub_f32 v29, v29, v125
    v_exp_f32 v29, v29
    v_sub_f32 v30, v30, v125
    v_exp_f32 v30, v30
    v_sub_f32 v31, v31, v125
    v_exp_f32 v31, v31
    s_setprio 2
    v_sub_f32 v32, v32, v4
    v_exp_f32 v32, v32
    v_sub_f32 v33, v33, v4
    v_exp_f32 v33, v33
    v_sub_f32 v34, v34, v4
    v_exp_f32 v34, v34
    v_smfmac_f32_32x32x32_bf16 v[160:175], v[180:183], v[24:31], v15
    v_sub_f32 v35, v35, v4
    v_exp_f32 v35, v35
    v_sub_f32 v36, v36, v4
    v_exp_f32 v36, v36
    v_sub_f32 v37, v37, v4
    v_exp_f32 v37, v37
    s_waitcnt lgkmcnt(0)
    v_mfma_f32_32x32x16_bf16 v[16:31], v[192:195], v[120:123], 0
    v_sub_f32 v38, v38, v4
    v_exp_f32 v38, v38
    v_sub_f32 v39, v39, v4
    v_exp_f32 v39, v39
    v_sub_f32 v40, v40, v4
    v_exp_f32 v40, v40
    v_sub_f32 v41, v41, v4
    v_exp_f32 v41, v41
    v_smfmac_f32_32x32x32_bf16 v[200:215], v[176:179], v[32:39], v15
    buffer_load_dwordx4 v[236:239], v3, s[40:43], s66 offen offset:3072 sc1
    v_sub_f32 v42, v42, v4
    v_exp_f32 v42, v42
    v_sub_f32 v43, v43, v4
    v_exp_f32 v43, v43
    v_sub_f32 v44, v44, v4
    v_exp_f32 v44, v44
    v_sub_f32 v45, v45, v4
    v_exp_f32 v45, v45
    v_sub_f32 v46, v46, v4
    v_exp_f32 v46, v46
    v_sub_f32 v47, v47, v4
    v_exp_f32 v47, v47
    s_waitcnt vmcnt(63)
    s_barrier
    s_setprio 1
    v_sub_f32 v16, v16, v125
    v_exp_f32 v16, v16
    v_sub_f32 v17, v17, v125
    v_exp_f32 v17, v17
    v_sub_f32 v18, v18, v125
    v_exp_f32 v18, v18
    v_smfmac_f32_32x32x32_bf16 v[200:215], v[180:183], v[40:47], v15
    s_mov_b64 exec, s[60:61]
    ds_read_b128 v[176:179], v1 offset:9216
    ds_read_b128 v[180:183], v1 offset:9472
    s_mov_b64 exec, -1
    v_sub_f32 v19, v19, v125
    v_exp_f32 v19, v19
    v_sub_f32 v20, v20, v125
    v_exp_f32 v20, v20
    v_sub_f32 v21, v21, v125
    v_exp_f32 v21, v21
    v_mfma_f32_32x32x16_bf16 v[32:47], v[192:195], v[196:199], 0
    ds_read_b128 v[192:195], v1 offset:8192
    v_sub_f32 v22, v22, v125
    v_exp_f32 v22, v22
    v_sub_f32 v23, v23, v125
    v_exp_f32 v23, v23
    v_sub_f32 v24, v24, v125
    v_exp_f32 v24, v24
    v_sub_f32 v25, v25, v125
    v_exp_f32 v25, v25
    v_smfmac_f32_32x32x32_bf16 v[160:175], v[184:187], v[16:23], v15
    s_add_u32 m0, s62, 0
    s_add_u32 s98, s55, 524288
    buffer_load_dwordx4 v6, s[28:31], s98 offen lds
    v_sub_f32 v26, v26, v125
    v_exp_f32 v26, v26
    v_sub_f32 v27, v27, v125
    v_exp_f32 v27, v27
    v_sub_f32 v28, v28, v125
    v_exp_f32 v28, v28
    v_sub_f32 v29, v29, v125
    v_exp_f32 v29, v29
    v_sub_f32 v30, v30, v125
    v_exp_f32 v30, v30
    v_sub_f32 v31, v31, v125
    v_exp_f32 v31, v31
    s_setprio 0
    v_sub_f32 v32, v32, v4
    v_exp_f32 v32, v32
    v_sub_f32 v33, v33, v4
    v_exp_f32 v33, v33
    v_sub_f32 v34, v34, v4
    v_exp_f32 v34, v34
    v_smfmac_f32_32x32x32_bf16 v[160:175], v[188:191], v[24:31], v15
    v_sub_f32 v35, v35, v4
    v_exp_f32 v35, v35
    v_sub_f32 v36, v36, v4
    v_exp_f32 v36, v36
    v_sub_f32 v37, v37, v4
    v_exp_f32 v37, v37
    s_waitcnt lgkmcnt(0)
    v_mfma_f32_32x32x16_bf16 v[16:31], v[192:195], v[120:123], 0
    v_sub_f32 v38, v38, v4
    v_exp_f32 v38, v38
    v_sub_f32 v39, v39, v4
    v_exp_f32 v39, v39
    v_sub_f32 v40, v40, v4
    v_exp_f32 v40, v40
    v_sub_f32 v41, v41, v4
    v_exp_f32 v41, v41
    v_smfmac_f32_32x32x32_bf16 v[200:215], v[184:187], v[32:39], v15
    s_add_u32 m0, s62, 8192
    s_add_u32 s98, s55, 589824
    buffer_load_dwordx4 v6, s[28:31], s98 offen lds
    ds_read_b64_tr_b16 v[128:129], v8 offset:0
    ds_read_b64_tr_b16 v[130:131], v8 offset:1024
    ds_read_b64_tr_b16 v[132:133], v9 offset:0
    ds_read_b64_tr_b16 v[134:135], v9 offset:1024
    v_sub_f32 v42, v42, v4
    v_exp_f32 v42, v42
    v_sub_f32 v43, v43, v4
    v_exp_f32 v43, v43
    v_sub_f32 v44, v44, v4
    v_exp_f32 v44, v44
    v_sub_f32 v45, v45, v4
    v_exp_f32 v45, v45
    v_sub_f32 v46, v46, v4
    v_exp_f32 v46, v46
    v_sub_f32 v47, v47, v4
    v_exp_f32 v47, v47
    s_setprio 3
    v_sub_f32 v16, v16, v125
    v_exp_f32 v16, v16
    v_sub_f32 v17, v17, v125
    v_exp_f32 v17, v17
    v_sub_f32 v18, v18, v125
    v_exp_f32 v18, v18
    v_smfmac_f32_32x32x32_bf16 v[200:215], v[188:191], v[40:47], v15
    s_mov_b64 exec, s[60:61]
    ds_read_b128 v[184:187], v1 offset:13312
    ds_read_b128 v[188:191], v1 offset:13568
    s_mov_b64 exec, -1
    v_sub_f32 v19, v19, v125
    v_exp_f32 v19, v19
    v_sub_f32 v20, v20, v125
    v_exp_f32 v20, v20
    v_sub_f32 v21, v21, v125
    v_exp_f32 v21, v21
    v_mfma_f32_32x32x16_bf16 v[32:47], v[192:195], v[196:199], 0
    ds_read_b128 v[192:195], v1 offset:12288
    v_sub_f32 v22, v22, v125
    v_exp_f32 v22, v22
    v_sub_f32 v23, v23, v125
    v_exp_f32 v23, v23
    v_sub_f32 v24, v24, v125
    v_exp_f32 v24, v24
    v_sub_f32 v25, v25, v125
    v_exp_f32 v25, v25
    v_smfmac_f32_32x32x32_bf16 v[160:175], v[176:179], v[16:23], v15
    s_add_u32 m0, s62, 16384
    s_add_u32 s98, s55, 655360
    buffer_load_dwordx4 v6, s[28:31], s98 offen lds
    ds_read_b64_tr_b16 v[136:137], v8 offset:2048
    ds_read_b64_tr_b16 v[138:139], v8 offset:3072
    ds_read_b64_tr_b16 v[140:141], v9 offset:2048
    ds_read_b64_tr_b16 v[142:143], v9 offset:3072
    v_sub_f32 v26, v26, v125
    v_exp_f32 v26, v26
    v_sub_f32 v27, v27, v125
    v_exp_f32 v27, v27
    v_sub_f32 v28, v28, v125
    v_exp_f32 v28, v28
    v_sub_f32 v29, v29, v125
    v_exp_f32 v29, v29
    v_sub_f32 v30, v30, v125
    v_exp_f32 v30, v30
    v_sub_f32 v31, v31, v125
    v_exp_f32 v31, v31
    s_setprio 2
    v_sub_f32 v32, v32, v4
    v_exp_f32 v32, v32
    v_sub_f32 v33, v33, v4
    v_exp_f32 v33, v33
    v_sub_f32 v34, v34, v4
    v_exp_f32 v34, v34
    v_smfmac_f32_32x32x32_bf16 v[160:175], v[180:183], v[24:31], v15
    v_sub_f32 v35, v35, v4
    v_exp_f32 v35, v35
    v_sub_f32 v36, v36, v4
    v_exp_f32 v36, v36
    v_sub_f32 v37, v37, v4
    v_exp_f32 v37, v37
    s_waitcnt lgkmcnt(0)
    v_mfma_f32_32x32x16_bf16 v[16:31], v[192:195], v[120:123], 0
    v_sub_f32 v38, v38, v4
    v_exp_f32 v38, v38
    v_sub_f32 v39, v39, v4
    v_exp_f32 v39, v39
    v_sub_f32 v40, v40, v4
    v_exp_f32 v40, v40
    v_sub_f32 v41, v41, v4
    v_exp_f32 v41, v41
    v_smfmac_f32_32x32x32_bf16 v[200:215], v[176:179], v[32:39], v15
    s_add_u32 m0, s62, 24576
    s_add_u32 s98, s55, 720896
    buffer_load_dwordx4 v6, s[28:31], s98 offen lds
    ds_read_b64_tr_b16 v[144:145], v8 offset:4096
    ds_read_b64_tr_b16 v[146:147], v8 offset:5120
    ds_read_b64_tr_b16 v[148:149], v9 offset:4096
    ds_read_b64_tr_b16 v[150:151], v9 offset:5120
    v_sub_f32 v42, v42, v4
    v_exp_f32 v42, v42
    v_sub_f32 v43, v43, v4
    v_exp_f32 v43, v43
    v_sub_f32 v44, v44, v4
    v_exp_f32 v44, v44
    v_sub_f32 v45, v45, v4
    v_exp_f32 v45, v45
    v_sub_f32 v46, v46, v4
    v_exp_f32 v46, v46
    v_sub_f32 v47, v47, v4
    v_exp_f32 v47, v47
    s_setprio 1
    v_sub_f32 v16, v16, v125
    v_exp_f32 v16, v16
    v_sub_f32 v17, v17, v125
    v_exp_f32 v17, v17
    v_sub_f32 v18, v18, v125
    v_exp_f32 v18, v18
    v_smfmac_f32_32x32x32_bf16 v[200:215], v[180:183], v[40:47], v15
    s_mov_b64 exec, s[60:61]
    ds_read_b128 v[176:179], v1 offset:17408
    ds_read_b128 v[180:183], v1 offset:17664
    s_mov_b64 exec, -1
    v_sub_f32 v19, v19, v125
    v_exp_f32 v19, v19
    v_sub_f32 v20, v20, v125
    v_exp_f32 v20, v20
    v_sub_f32 v21, v21, v125
    v_exp_f32 v21, v21
    v_mfma_f32_32x32x16_bf16 v[32:47], v[192:195], v[196:199], 0
    ds_read_b128 v[192:195], v1 offset:16384
    v_sub_f32 v22, v22, v125
    v_exp_f32 v22, v22
    v_sub_f32 v23, v23, v125
    v_exp_f32 v23, v23
    v_sub_f32 v24, v24, v125
    v_exp_f32 v24, v24
    v_sub_f32 v25, v25, v125
    v_exp_f32 v25, v25
    v_smfmac_f32_32x32x32_bf16 v[160:175], v[184:187], v[16:23], v15
    s_add_u32 m0, s62, 32768
    s_add_u32 s98, s55, 786432
    buffer_load_dwordx4 v6, s[28:31], s98 offen lds
    ds_read_b64_tr_b16 v[152:153], v8 offset:6144
    ds_read_b64_tr_b16 v[154:155], v8 offset:7168
    ds_read_b64_tr_b16 v[156:157], v9 offset:6144
    ds_read_b64_tr_b16 v[158:159], v9 offset:7168
    v_sub_f32 v26, v26, v125
    v_exp_f32 v26, v26
    v_sub_f32 v27, v27, v125
    v_exp_f32 v27, v27
    v_sub_f32 v28, v28, v125
    v_exp_f32 v28, v28
    v_sub_f32 v29, v29, v125
    v_exp_f32 v29, v29
    v_sub_f32 v30, v30, v125
    v_exp_f32 v30, v30
    v_sub_f32 v31, v31, v125
    v_exp_f32 v31, v31
    s_setprio 0
    v_sub_f32 v32, v32, v4
    v_exp_f32 v32, v32
    v_sub_f32 v33, v33, v4
    v_exp_f32 v33, v33
    v_sub_f32 v34, v34, v4
    v_exp_f32 v34, v34
    v_smfmac_f32_32x32x32_bf16 v[160:175], v[188:191], v[24:31], v15
    v_sub_f32 v35, v35, v4
    v_exp_f32 v35, v35
    v_sub_f32 v36, v36, v4
    v_exp_f32 v36, v36
    v_sub_f32 v37, v37, v4
    v_exp_f32 v37, v37
    s_waitcnt lgkmcnt(0)
    v_mfma_f32_32x32x16_bf16 v[16:31], v[192:195], v[120:123], 0
    v_sub_f32 v38, v38, v4
    v_exp_f32 v38, v38
    v_sub_f32 v39, v39, v4
    v_exp_f32 v39, v39
    v_sub_f32 v40, v40, v4
    v_exp_f32 v40, v40
    v_sub_f32 v41, v41, v4
    v_exp_f32 v41, v41
    v_smfmac_f32_32x32x32_bf16 v[200:215], v[184:187], v[32:39], v15
    s_add_u32 m0, s62, 40960
    s_add_u32 s98, s55, 851968
    buffer_load_dwordx4 v6, s[28:31], s98 offen lds
    v_sub_f32 v42, v42, v4
    v_exp_f32 v42, v42
    v_sub_f32 v43, v43, v4
    v_exp_f32 v43, v43
    v_sub_f32 v44, v44, v4
    v_exp_f32 v44, v44
    v_sub_f32 v45, v45, v4
    v_exp_f32 v45, v45
    v_sub_f32 v46, v46, v4
    v_exp_f32 v46, v46
    v_sub_f32 v47, v47, v4
    v_exp_f32 v47, v47
    s_setprio 3
    v_sub_f32 v16, v16, v125
    v_exp_f32 v16, v16
    v_sub_f32 v17, v17, v125
    v_exp_f32 v17, v17
    v_sub_f32 v18, v18, v125
    v_exp_f32 v18, v18
    v_smfmac_f32_32x32x32_bf16 v[200:215], v[188:191], v[40:47], v15
    s_mov_b64 exec, s[60:61]
    ds_read_b128 v[184:187], v1 offset:21504
    ds_read_b128 v[188:191], v1 offset:21760
    s_mov_b64 exec, -1
    v_sub_f32 v19, v19, v125
    v_exp_f32 v19, v19
    v_sub_f32 v20, v20, v125
    v_exp_f32 v20, v20
    v_sub_f32 v21, v21, v125
    v_exp_f32 v21, v21
    v_mfma_f32_32x32x16_bf16 v[32:47], v[192:195], v[196:199], 0
    ds_read_b128 v[192:195], v1 offset:20480
    v_sub_f32 v22, v22, v125
    v_exp_f32 v22, v22
    v_sub_f32 v23, v23, v125
    v_exp_f32 v23, v23
    v_sub_f32 v24, v24, v125
    v_exp_f32 v24, v24
    v_sub_f32 v25, v25, v125
    v_exp_f32 v25, v25
    v_smfmac_f32_32x32x32_bf16 v[160:175], v[176:179], v[16:23], v15
    s_add_u32 m0, s62, 49152
    s_add_u32 s98, s55, 917504
    buffer_load_dwordx4 v6, s[28:31], s98 offen lds
    v_sub_f32 v26, v26, v125
    v_exp_f32 v26, v26
    v_sub_f32 v27, v27, v125
    v_exp_f32 v27, v27
    v_sub_f32 v28, v28, v125
    v_exp_f32 v28, v28
    v_sub_f32 v29, v29, v125
    v_exp_f32 v29, v29
    v_sub_f32 v30, v30, v125
    v_exp_f32 v30, v30
    v_sub_f32 v31, v31, v125
    v_exp_f32 v31, v31
    s_setprio 2
    v_sub_f32 v32, v32, v4
    v_exp_f32 v32, v32
    v_sub_f32 v33, v33, v4
    v_exp_f32 v33, v33
    v_sub_f32 v34, v34, v4
    v_exp_f32 v34, v34
    v_smfmac_f32_32x32x32_bf16 v[160:175], v[180:183], v[24:31], v15
    v_sub_f32 v35, v35, v4
    v_exp_f32 v35, v35
    v_sub_f32 v36, v36, v4
    v_exp_f32 v36, v36
    v_sub_f32 v37, v37, v4
    v_exp_f32 v37, v37
    s_waitcnt lgkmcnt(0)
    v_mfma_f32_32x32x16_bf16 v[16:31], v[192:195], v[120:123], 0
    v_sub_f32 v38, v38, v4
    v_exp_f32 v38, v38
    v_sub_f32 v39, v39, v4
    v_exp_f32 v39, v39
    v_sub_f32 v40, v40, v4
    v_exp_f32 v40, v40
    v_sub_f32 v41, v41, v4
    v_exp_f32 v41, v41
    v_smfmac_f32_32x32x32_bf16 v[200:215], v[176:179], v[32:39], v15
    s_add_u32 m0, s62, 57344
    s_add_u32 s98, s55, 983040
    buffer_load_dwordx4 v6, s[28:31], s98 offen lds
    v_sub_f32 v42, v42, v4
    v_exp_f32 v42, v42
    v_sub_f32 v43, v43, v4
    v_exp_f32 v43, v43
    v_sub_f32 v44, v44, v4
    v_exp_f32 v44, v44
    v_sub_f32 v45, v45, v4
    v_exp_f32 v45, v45
    v_sub_f32 v46, v46, v4
    v_exp_f32 v46, v46
    v_sub_f32 v47, v47, v4
    v_exp_f32 v47, v47
    s_barrier
    s_setprio 1
    v_sub_f32 v16, v16, v125
    v_exp_f32 v16, v16
    v_sub_f32 v17, v17, v125
    v_exp_f32 v17, v17
    v_sub_f32 v18, v18, v125
    v_exp_f32 v18, v18
    v_smfmac_f32_32x32x32_bf16 v[200:215], v[180:183], v[40:47], v15
    s_mov_b64 exec, s[60:61]
    ds_read_b128 v[176:179], v1 offset:25600
    ds_read_b128 v[180:183], v1 offset:25856
    s_mov_b64 exec, -1
    v_sub_f32 v19, v19, v125
    v_exp_f32 v19, v19
    v_sub_f32 v20, v20, v125
    v_exp_f32 v20, v20
    v_sub_f32 v21, v21, v125
    v_exp_f32 v21, v21
    v_mfma_f32_32x32x16_bf16 v[32:47], v[192:195], v[196:199], 0
    ds_read_b128 v[192:195], v1 offset:24576
    v_sub_f32 v22, v22, v125
    v_exp_f32 v22, v22
    v_sub_f32 v23, v23, v125
    v_exp_f32 v23, v23
    v_sub_f32 v24, v24, v125
    v_exp_f32 v24, v24
    v_sub_f32 v25, v25, v125
    v_exp_f32 v25, v25
    v_smfmac_f32_32x32x32_bf16 v[160:175], v[184:187], v[16:23], v15
    s_add_u32 m0, s62, 98304
    s_add_u32 s98, s55, 1048576
    buffer_load_dwordx4 v6, s[28:31], s98 offen lds
    v_sub_f32 v26, v26, v125
    v_exp_f32 v26, v26
    v_sub_f32 v27, v27, v125
    v_exp_f32 v27, v27
    v_sub_f32 v28, v28, v125
    v_exp_f32 v28, v28
    v_sub_f32 v29, v29, v125
    v_exp_f32 v29, v29
    v_sub_f32 v30, v30, v125
    v_exp_f32 v30, v30
    v_sub_f32 v31, v31, v125
    v_exp_f32 v31, v31
    s_setprio 0
    v_sub_f32 v32, v32, v4
    v_exp_f32 v32, v32
    v_sub_f32 v33, v33, v4
    v_exp_f32 v33, v33
    v_sub_f32 v34, v34, v4
    v_exp_f32 v34, v34
    v_smfmac_f32_32x32x32_bf16 v[160:175], v[188:191], v[24:31], v15
    v_sub_f32 v35, v35, v4
    v_exp_f32 v35, v35
    v_sub_f32 v36, v36, v4
    v_exp_f32 v36, v36
    v_sub_f32 v37, v37, v4
    v_exp_f32 v37, v37
    s_waitcnt lgkmcnt(0)
    v_mfma_f32_32x32x16_bf16 v[16:31], v[192:195], v[120:123], 0
    v_sub_f32 v38, v38, v4
    v_exp_f32 v38, v38
    v_sub_f32 v39, v39, v4
    v_exp_f32 v39, v39
    v_sub_f32 v40, v40, v4
    v_exp_f32 v40, v40
    v_sub_f32 v41, v41, v4
    v_exp_f32 v41, v41
    v_smfmac_f32_32x32x32_bf16 v[200:215], v[184:187], v[32:39], v15
    s_add_u32 m0, s62, 106496
    s_add_u32 s98, s55, 1114112
    buffer_load_dwordx4 v6, s[28:31], s98 offen lds
    v_sub_f32 v42, v42, v4
    v_exp_f32 v42, v42
    v_sub_f32 v43, v43, v4
    v_exp_f32 v43, v43
    v_sub_f32 v44, v44, v4
    v_exp_f32 v44, v44
    v_sub_f32 v45, v45, v4
    v_exp_f32 v45, v45
    v_sub_f32 v46, v46, v4
    v_exp_f32 v46, v46
    v_sub_f32 v47, v47, v4
    v_exp_f32 v47, v47
    s_setprio 3
    v_sub_f32 v16, v16, v125
    v_exp_f32 v16, v16
    v_sub_f32 v17, v17, v125
    v_exp_f32 v17, v17
    v_sub_f32 v18, v18, v125
    v_exp_f32 v18, v18
    v_smfmac_f32_32x32x32_bf16 v[200:215], v[188:191], v[40:47], v15
    s_mov_b64 exec, s[60:61]
    ds_read_b128 v[184:187], v1 offset:29696
    ds_read_b128 v[188:191], v1 offset:29952
    s_mov_b64 exec, -1
    v_sub_f32 v19, v19, v125
    v_exp_f32 v19, v19
    v_sub_f32 v20, v20, v125
    v_exp_f32 v20, v20
    v_sub_f32 v21, v21, v125
    v_exp_f32 v21, v21
    v_mfma_f32_32x32x16_bf16 v[32:47], v[192:195], v[196:199], 0
    ds_read_b128 v[192:195], v1 offset:28672
    v_sub_f32 v22, v22, v125
    v_exp_f32 v22, v22
    v_sub_f32 v23, v23, v125
    v_exp_f32 v23, v23
    v_sub_f32 v24, v24, v125
    v_exp_f32 v24, v24
    v_sub_f32 v25, v25, v125
    v_exp_f32 v25, v25
    v_smfmac_f32_32x32x32_bf16 v[160:175], v[176:179], v[16:23], v15
    s_add_u32 m0, s62, 114688
    s_add_u32 s98, s55, 1179648
    buffer_load_dwordx4 v6, s[28:31], s98 offen lds
    v_sub_f32 v26, v26, v125
    v_exp_f32 v26, v26
    v_sub_f32 v27, v27, v125
    v_exp_f32 v27, v27
    v_sub_f32 v28, v28, v125
    v_exp_f32 v28, v28
    v_sub_f32 v29, v29, v125
    v_exp_f32 v29, v29
    v_sub_f32 v30, v30, v125
    v_exp_f32 v30, v30
    v_sub_f32 v31, v31, v125
    v_exp_f32 v31, v31
    s_setprio 2
    v_sub_f32 v32, v32, v4
    v_exp_f32 v32, v32
    v_sub_f32 v33, v33, v4
    v_exp_f32 v33, v33
    v_sub_f32 v34, v34, v4
    v_exp_f32 v34, v34
    v_smfmac_f32_32x32x32_bf16 v[160:175], v[180:183], v[24:31], v15
    v_sub_f32 v35, v35, v4
    v_exp_f32 v35, v35
    v_sub_f32 v36, v36, v4
    v_exp_f32 v36, v36
    v_sub_f32 v37, v37, v4
    v_exp_f32 v37, v37
    s_waitcnt lgkmcnt(0)
    v_mfma_f32_32x32x16_bf16 v[16:31], v[192:195], v[120:123], 0
    v_sub_f32 v38, v38, v4
    v_exp_f32 v38, v38
    v_sub_f32 v39, v39, v4
    v_exp_f32 v39, v39
    v_sub_f32 v40, v40, v4
    v_exp_f32 v40, v40
    v_sub_f32 v41, v41, v4
    v_exp_f32 v41, v41
    v_smfmac_f32_32x32x32_bf16 v[200:215], v[176:179], v[32:39], v15
    s_add_u32 m0, s62, 122880
    s_add_u32 s98, s55, 1245184
    buffer_load_dwordx4 v6, s[28:31], s98 offen lds
    v_sub_f32 v42, v42, v4
    v_exp_f32 v42, v42
    v_sub_f32 v43, v43, v4
    v_exp_f32 v43, v43
    v_sub_f32 v44, v44, v4
    v_exp_f32 v44, v44
    v_sub_f32 v45, v45, v4
    v_exp_f32 v45, v45
    v_sub_f32 v46, v46, v4
    v_exp_f32 v46, v46
    v_sub_f32 v47, v47, v4
    v_exp_f32 v47, v47
    s_setprio 1
    v_sub_f32 v16, v16, v125
    v_exp_f32 v16, v16
    v_sub_f32 v17, v17, v125
    v_exp_f32 v17, v17
    v_sub_f32 v18, v18, v125
    v_exp_f32 v18, v18
    v_smfmac_f32_32x32x32_bf16 v[200:215], v[180:183], v[40:47], v15
    v_sub_f32 v19, v19, v125
    v_exp_f32 v19, v19
    v_sub_f32 v20, v20, v125
    v_exp_f32 v20, v20
    v_sub_f32 v21, v21, v125
    v_exp_f32 v21, v21
    v_mfma_f32_32x32x16_bf16 v[32:47], v[192:195], v[196:199], 0
    v_sub_f32 v22, v22, v125
    v_exp_f32 v22, v22
    v_sub_f32 v23, v23, v125
    v_exp_f32 v23, v23
    v_sub_f32 v24, v24, v125
    v_exp_f32 v24, v24
    v_sub_f32 v25, v25, v125
    v_exp_f32 v25, v25
    v_smfmac_f32_32x32x32_bf16 v[160:175], v[184:187], v[16:23], v15
    s_add_u32 s66, s66, 16384
    buffer_load_dwordx4 v[240:243], v3, s[40:43], s66 offen offset:0 sc1
    buffer_load_dwordx4 v[244:247], v3, s[40:43], s66 offen offset:1024 sc1
    v_sub_f32 v26, v26, v125
    v_exp_f32 v26, v26
    v_sub_f32 v27, v27, v125
    v_exp_f32 v27, v27
    v_sub_f32 v28, v28, v125
    v_exp_f32 v28, v28
    v_sub_f32 v29, v29, v125
    v_exp_f32 v29, v29
    v_sub_f32 v30, v30, v125
    v_exp_f32 v30, v30
    v_sub_f32 v31, v31, v125
    v_exp_f32 v31, v31
    s_setprio 0
    v_sub_f32 v32, v32, v4
    v_exp_f32 v32, v32
    v_sub_f32 v33, v33, v4
    v_exp_f32 v33, v33
    v_sub_f32 v34, v34, v4
    v_exp_f32 v34, v34
    v_smfmac_f32_32x32x32_bf16 v[160:175], v[188:191], v[24:31], v15
    v_sub_f32 v35, v35, v4
    v_exp_f32 v35, v35
    v_sub_f32 v36, v36, v4
    v_exp_f32 v36, v36
    v_sub_f32 v37, v37, v4
    v_exp_f32 v37, v37
    s_waitcnt lgkmcnt(0)
    v_sub_f32 v38, v38, v4
    v_exp_f32 v38, v38
    v_sub_f32 v39, v39, v4
    v_exp_f32 v39, v39
    v_sub_f32 v40, v40, v4
    v_exp_f32 v40, v40
    v_sub_f32 v41, v41, v4
    v_exp_f32 v41, v41
    v_smfmac_f32_32x32x32_bf16 v[200:215], v[184:187], v[32:39], v15
    buffer_load_dwordx4 v[248:251], v3, s[40:43], s66 offen offset:2048 sc1
    buffer_load_dwordx4 v[252:255], v3, s[40:43], s66 offen offset:3072 sc1
    v_sub_f32 v42, v42, v4
    v_exp_f32 v42, v42
    v_sub_f32 v43, v43, v4
    v_exp_f32 v43, v43
    v_sub_f32 v44, v44, v4
    v_exp_f32 v44, v44
    v_sub_f32 v45, v45, v4
    v_exp_f32 v45, v45
    v_sub_f32 v46, v46, v4
    v_exp_f32 v46, v46
    v_sub_f32 v47, v47, v4
    v_exp_f32 v47, v47
    s_branch L_tail
L_hp_s:
    s_add_u32 s3, s3, 1
    s_cmp_gt_u32 s3, 200000
    s_cbranch_scc1 L_hp_s_r
    s_sleep 16
    buffer_load_dword v12, v13, s[40:43], s66 offen sc1
    s_waitcnt vmcnt(0)
    v_cmp_ne_u32 vcc, s49, v12
    s_nop 0
    s_cbranch_vccnz L_hp_s
    s_branch L_hp_s_r
.section .rodata,"a"
.p2align 6
.amdhsa_kernel gated_mix__grouped_kv_mqa__glu_gated_geglu__prompt_kernel
  .amdhsa_next_free_vgpr 256
  .amdhsa_next_free_sgpr 102
  .amdhsa_accum_offset 256
  .amdhsa_group_segment_fixed_size 0
  .amdhsa_kernarg_size 104
  .amdhsa_user_sgpr_count 2
  .amdhsa_user_sgpr_kernarg_segment_ptr 1
  .amdhsa_system_sgpr_workgroup_id_x 1
.end_amdhsa_kernel
```
